```python
import torch

def _softmax(x, axis=-1):
    return torch.softmax(x, dim=axis)
def _gelu(x):
    return torch.nn.functional.gelu(x, approximate="tanh")
def _silu(x):
    return torch.nn.functional.silu(x)
def _sigmoid(x):
    return torch.sigmoid(x)
def _layernorm(x, axis=-1, eps=1e-5):
    m = x.mean(dim=axis, keepdim=True)
    v = x.var(dim=axis, keepdim=True, unbiased=False)
    return (x - m) / torch.sqrt(v + eps)
def _scatter_add(tgt, idx, src, axis=0):
    return tgt.clone().index_add_(axis, idx, src)
def _segment_sum(src, seg, n):
    out = torch.zeros((n,) + src.shape[1:], dtype=src.dtype)
    return out.index_add_(0, seg, src)
def _pad(x, pw):
    flat = tuple(v for pair in reversed(pw) for v in pair)
    return torch.nn.functional.pad(x, flat)

kernel_name = 'concat_heads__linear_kernel_hedgehog__mha_block__prompt'

def setup_inputs():

    _w = (lambda a: (lambda t: t.to(torch.bfloat16) if t.is_floating_point() else t)(torch.as_tensor(a)))
    def _A_setup():
        B, S, D, H = 1, 2048, 1024, 32
        Dh = D // H
        return {
            "x": _w((lambda *s: torch.randn(*s, dtype=torch.bfloat16) * 0.4)(B, S, D)),
            "wqkv": _w((lambda *s: torch.randn(*s, dtype=torch.bfloat16) * 0.4)(D, 3 * D)),
            "w_phi": _w((lambda *s: torch.randn(*s, dtype=torch.bfloat16) * 0.4)(H, Dh, Dh) * (Dh ** -0.5)),
            "wo": _w((lambda *s: torch.randn(*s, dtype=torch.bfloat16) * 0.05)(D, D)),
        }
    _A_in = _A_setup()

    def _B_setup():
        B, S, D, H = 1, 2048, 1024, 32
        return {
            "x": _w((lambda *s: torch.randn(*s, dtype=torch.bfloat16) * 0.2)(B, S, D)),
            "wqkv": _w((lambda *s: torch.randn(*s, dtype=torch.bfloat16) * 0.2)(D, 3 * D)),
            "wo": _w((lambda *s: torch.randn(*s, dtype=torch.bfloat16) * 0.05)(D, D)),
        }
    _B_in = _B_setup()

    return {
        "A_x": _A_in["x"],
        "A_wqkv": _A_in["wqkv"],
        "A_w_phi": _A_in["w_phi"],
        "A_wo": _A_in["wo"],
        "B_x": _B_in["x"],
        "B_wqkv": _B_in["wqkv"],
        "B_wo": _B_in["wo"],
    }

def reference(A_x, A_wqkv, A_w_phi, A_wo, B_x, B_wqkv, B_wo):
    def _A_ref(x, wqkv, w_phi, wo):
        B, S, D = x.shape
        H = 32; Dh = D // H
        qkv = (lambda x, *d: x.permute(*d))((x @ wqkv).reshape(B, S, 3, H, Dh), 2, 0, 3, 1, 4)
        q, k, v = qkv[0], qkv[1], qkv[2]
        pq = torch.einsum("bhsd,hdf->bhsf", q, w_phi)
        pk = torch.einsum("bhsd,hdf->bhsf", k, w_phi)
        phi_q = torch.concatenate([_softmax(pq, axis=-1), _softmax(-pq, axis=-1)], axis=-1)
        phi_k = torch.concatenate([_softmax(pk, axis=-1), _softmax(-pk, axis=-1)], axis=-1)
        kv = torch.einsum("bhsf,bhsd->bhfd", phi_k, v)
        z  = torch.einsum("bhsf->bhf", phi_k)
        num = torch.einsum("bhqf,bhfd->bhqd", phi_q, kv)
        den = torch.einsum("bhqf,bhf->bhq", phi_q, z)[..., None] + 1e-6
        o = num / den
        return (lambda x, *d: x.permute(*d))(o, 0, 2, 1, 3).reshape(B, S, D) @ wo

    def _B_ref(x, wqkv, wo):
        B, S, D = x.shape
        H = 32
        Dh = D // H
        qkv = (lambda x, *d: x.permute(*d))((x @ wqkv).reshape(B, S, 3, H, Dh), 2, 0, 3, 1, 4)
        q, k, v = qkv[0], qkv[1], qkv[2]
        scores = torch.einsum("bhqd,bhkd->bhqk", q, k) * (Dh ** -0.5)
        p = _softmax(scores, axis=-1)
        o = torch.einsum("bhqk,bhkd->bhqd", p, v)
        return (lambda x, *d: x.permute(*d))(o, 0, 2, 1, 3).reshape(B, S, D) @ wo

    a = _A_ref(A_x, A_wqkv, A_w_phi, A_wo)
    b = _B_ref(B_x, B_wqkv, B_wo)
    return torch.concatenate([a, b], axis=-1)
```

```asm
; @launch grid=(256,1,1) block=(512,1,1) lds=163840
.amdgcn_target "amdgcn-amd-amdhsa--gfx950"
.text
.p2align 12
.text
.globl concat_heads__linear_kernel_hedgehog__mha_block__prompt_kernel
.p2align 8
.type concat_heads__linear_kernel_hedgehog__mha_block__prompt_kernel,@function
concat_heads__linear_kernel_hedgehog__mha_block__prompt_kernel:
    s_cmp_ge_u32 s2, 256
    s_cbranch_scc1 END_1
    s_load_dwordx8 s[24:31], s[0:1], 0
    s_load_dwordx4 s[32:35], s[0:1], 32
    v_lshrrev_b32 v12, 6, v0
    v_and_b32 v1, 63, v0
    s_and_b32 s4, s2, 1
    v_readfirstlane_b32 s6, v12
    s_lshl_b32 s4, s4, 2
    s_bfe_u32 s50, s2, 0x20003
    s_add_u32 s4, s4, s50
    s_bfe_u32 s5, s2, 0x20001
    s_lshl_b32 s5, s5, 2
    s_bfe_u32 s50, s2, 0x20005
    s_add_u32 s5, s5, s50
    v_lshrrev_b32 v12, 3, v1
    v_and_b32 v14, 7, v1
    v_lshrrev_b32 v15, 4, v1
    v_xor_b32 v16, v14, v15
    v_lshlrev_b32 v16, 4, v16
    v_lshl_add_u32 v2, v12, 11, v16
    v_xor_b32_e64 v3, 64, v2
    v_add_u32 v3, 15360, v3
    s_lshl_b32 s40, s6, 16
    s_lshl_b32 s7, s4, 19
    s_add_u32 s40, s40, s7
    s_add_u32 s41, s40, 32768
    s_lshl_b32 s46, s6, 12
    s_add_u32 s47, s46, 2048
    s_add_u32 s69, s4, s5
    s_and_b32 s69, s69, 1
    s_lshl_b32 s63, s69, 7
    s_mov_b32 s65, s63
    s_mov_b32 s62, 0
    s_mov_b32 s10, 0x400000
    s_mov_b32 s11, 0x20000
    s_bitcmp1_b32 s2, 7
    s_waitcnt lgkmcnt(0)
    s_cselect_b32 s8, s24, s32
    s_cselect_b32 s9, s25, s33
    s_cselect_b32 s12, s26, s34
    s_cselect_b32 s13, s27, s35
    s_add_u32 m0, 0, s46
    s_add_u32 s67, s40, s65
    buffer_load_dwordx4 v2, s[8:11], s67 offen lds
    buffer_load_dwordx4 v3, s[8:11], s67 offen offset:1024 lds
    s_add_u32 m0, 0, s47
    s_add_u32 s67, s41, s65
    buffer_load_dwordx4 v2, s[8:11], s67 offen lds
    buffer_load_dwordx4 v3, s[8:11], s67 offen offset:1024 lds
    s_add_u32 s62, s62, 128
    s_xor_b32 s65, s62, s63
    s_load_dwordx2 s[16:17], s[0:1], 72
    s_load_dwordx4 s[96:99], s[0:1], 48
    s_load_dwordx2 s[100:101], s[0:1], 64
    s_and_b32 s7, s6, 1
    s_lshl_b32 s7, s7, 2
    v_and_b32 v16, 1, v15
    v_lshlrev_b32 v16, 1, v16
    v_xor_b32 v16, v16, v14
    v_xor_b32 v16, s7, v16
    v_lshlrev_b32_e64 v16, 4, v16
    v_mul_u32_u24 v4, 6144, v12
    v_add_u32 v4, v4, v16
    s_and_b32 s7, s6, 3
    s_mul_i32 s42, s7, 49152
    s_lshl_b32 s50, s5, 7
    s_add_u32 s42, s42, s50
    s_add_u32 s43, s42, 4096
    s_lshr_b32 s50, s6, 2
    s_lshl_b32 s50, s50, 11
    s_add_u32 s42, s42, s50
    s_lshl_b32 s44, s6, 10
    s_lshl_b32 s45, s7, 10
    s_add_u32 s45, s45, 8192
    s_mov_b32 s64, 0
    s_lshl_b32 s69, s69, 1
    s_mul_i32 s66, s69, 196608
    s_cmp_lt_u32 s6, 4
    s_cselect_b64 vcc, -1, 0
    s_mov_b32 s14, 0x600000
    s_mov_b32 s15, 0x20000
    s_add_u32 m0, 98304, s44
    s_add_u32 s68, s42, s66
    buffer_load_dwordx4 v4, s[12:15], s68 offen lds
    s_cbranch_vccz SK_2
    s_add_u32 m0, 98304, s45
    s_add_u32 s68, s43, s66
    buffer_load_dwordx4 v4, s[12:15], s68 offen lds
SK_2:
    s_add_u32 s64, s64, 1
    s_xor_b32 s66, s64, s69
    s_mul_i32 s66, s66, 196608
    s_add_u32 m0, 110592, s44
    s_add_u32 s68, s42, s66
    buffer_load_dwordx4 v4, s[12:15], s68 offen lds
    s_cbranch_vccnz SK_3
    s_add_u32 m0, 110592, s45
    s_add_u32 s68, s43, s66
    buffer_load_dwordx4 v4, s[12:15], s68 offen lds
SK_3:
    s_add_u32 s64, s64, 1
    s_xor_b32 s66, s64, s69
    s_mul_i32 s66, s66, 196608
    s_lshr_b32 s3, s2, 7
    s_xor_b32 s3, s3, 1
    s_mov_b32 s18, 268435456
    s_mov_b32 s19, 0x20000
    s_waitcnt lgkmcnt(0)
    s_lshl_b32 s7, s2, 3
    s_add_u32 s7, s7, s6
    s_cmp_lg_u32 s7, 7
    s_cbranch_scc1 NZ_4
    v_mov_b32 v224, 0
    v_mov_b32 v225, 0
    v_mov_b32 v226, 0
    v_mov_b32 v227, 0
    v_lshlrev_b32_e64 v17, 4, v1
    s_mov_b32 s7, 20447232
    s_mov_b32 s50, 20451328
    buffer_store_dwordx4 v[224:227], v17, s[16:19], s7 offen offset:0 sc1
    buffer_store_dwordx4 v[224:227], v17, s[16:19], s7 offen offset:1024 sc1
    buffer_store_dwordx4 v[224:227], v17, s[16:19], s7 offen offset:2048 sc1
    buffer_store_dwordx4 v[224:227], v17, s[16:19], s7 offen offset:3072 sc1
    buffer_store_dwordx4 v[224:227], v17, s[16:19], s50 offen sc1
NZ_4:
    s_cmp_lg_u32 s6, 6
    s_cbranch_scc1 CP_5
    s_getpc_b64 s[58:59]
PC1:
    s_lshr_b32 s7, s2, 3
    s_lshl_b32 s7, s7, 11
    v_and_b32 v30, 15, v1
    v_lshl_add_u32 v30, v30, 7, s7
    v_min_u32 v30, CODE_END-PC1-4, v30
    global_load_dword v31, v30, s[58:59]
CP_5:
    s_mov_b32 s20, s28
    s_mov_b32 s21, s29
    s_mov_b32 s22, 0x10000
    s_mov_b32 s23, 0x20000
    s_lshl_b32 s7, s5, 1
    s_lshr_b32 s50, s6, 2
    s_add_u32 s51, s7, s50
    s_cbranch_vccz NOPHI_6
    v_lshlrev_b32_e64 v16, 4, v1
    s_lshl_b32 s7, s5, 12
    s_add_u32 s7, s7, s44
    s_add_u32 m0, s44, 159744
    s_nop 0
    buffer_load_dwordx4 v16, s[20:23], s7 offen lds
NOPHI_6:
    s_mov_b32 s20, s100
    s_mov_b32 s21, s101
    s_mov_b32 s22, 256
    s_mov_b32 s24, 0x3fb8aa3b
    s_mov_b32 s25, s24
    s_mov_b32 s26, 0x7b800000
    v_and_b32 v12, 31, v1
    v_lshrrev_b32 v14, 5, v1
    s_and_b32 s7, s6, 3
    s_lshl_b32 s7, s7, 13
    v_and_b32 v15, 15, v1
    v_lshlrev_b32 v15, 7, v15
    v_add_u32_e64 v15, s7, v15
    v_bfe_u32 v16, v1, 1, 3
    v_lshrrev_b32 v17, 4, v1
    v_xor_b32 v16, v16, v17
    v_lshl_add_u32 v5, v16, 4, v15
    v_xor_b32_e64 v6, 64, v5
    v_bfe_u32 v18, v1, 2, 2
    v_lshl_add_u32 v18, v17, 3, v18
    v_bfe_u32 v19, v1, 3, 2
    v_bfe_u32 v20, v1, 1, 1
    v_lshl_add_u32 v19, v19, 1, v20
    s_lshr_b32 s7, s6, 2
    s_lshl_b32 s7, s7, 2
    v_xor_b32 v19, s7, v19
    v_lshlrev_b32 v19, 4, v19
    v_lshl_add_u32 v7, v18, 7, v19
    v_and_b32_e64 v20, 1, v1
    v_lshl_add_u32 v7, v20, 3, v7
    v_xor_b32 v8, 32, v7
    v_lshlrev_b32 v15, 2, v14
    v_sub_u32_e64 v15, v12, v15
    v_mov_b32 v17, 0x3f80
    v_mov_b32_e64 v18, 0x3f800000
    v_cmp_eq_u32 s[52:53], 0, v15
    v_cmp_eq_u32 s[54:55], 1, v15
    s_nop 1
    s_nop 0
    v_cndmask_b32 v36, 0, v17, s[52:53]
    v_cndmask_b32 v36, v36, v18, s[54:55]
    v_cmp_eq_u32 s[52:53], 2, v15
    v_cmp_eq_u32 s[54:55], 3, v15
    s_nop 1
    s_nop 0
    v_cndmask_b32 v37, 0, v17, s[52:53]
    v_cndmask_b32 v37, v37, v18, s[54:55]
    v_cmp_eq_u32 s[52:53], 8, v15
    v_cmp_eq_u32 s[54:55], 9, v15
    s_nop 1
    s_nop 0
    v_cndmask_b32 v38, 0, v17, s[52:53]
    v_cndmask_b32 v38, v38, v18, s[54:55]
    v_cmp_eq_u32 s[52:53], 10, v15
    v_cmp_eq_u32 s[54:55], 11, v15
    s_nop 1
    s_nop 0
    v_cndmask_b32 v39, 0, v17, s[52:53]
    v_cndmask_b32 v39, v39, v18, s[54:55]
    v_cmp_eq_u32 s[52:53], 16, v15
    v_cmp_eq_u32 s[54:55], 17, v15
    s_nop 1
    s_nop 0
    v_cndmask_b32 v40, 0, v17, s[52:53]
    v_cndmask_b32 v40, v40, v18, s[54:55]
    v_cmp_eq_u32 s[52:53], 18, v15
    v_cmp_eq_u32 s[54:55], 19, v15
    s_nop 1
    s_nop 0
    v_cndmask_b32 v41, 0, v17, s[52:53]
    v_cndmask_b32 v41, v41, v18, s[54:55]
    v_cmp_eq_u32 s[52:53], 24, v15
    v_cmp_eq_u32 s[54:55], 25, v15
    s_nop 1
    s_nop 0
    v_cndmask_b32 v42, 0, v17, s[52:53]
    v_cndmask_b32 v42, v42, v18, s[54:55]
    v_cmp_eq_u32 s[52:53], 26, v15
    v_cmp_eq_u32 s[54:55], 27, v15
    s_nop 1
    v_cndmask_b32 v43, 0, v17, s[52:53]
    v_cndmask_b32 v43, v43, v18, s[54:55]
    v_and_b32 v17, 7, v1
    v_cmp_eq_u32 s[52:53], 0, v17
    v_cmp_eq_u32 s[54:55], 4, v17
    v_mov_b32 v18, 0x3f803f80
    v_mov_b32 v26, 0xdddddddd
    v_cndmask_b32 v44, 0, v18, s[52:53]
    v_cndmask_b32 v45, 0, v18, s[52:53]
    v_cndmask_b32 v46, 0, v18, s[54:55]
    v_cndmask_b32 v47, 0, v18, s[54:55]
    v_mov_b32 v224, 0
    v_mov_b32 v225, 0
    v_mov_b32 v226, 0
    v_mov_b32 v227, 0
    v_mov_b32 v228, 0
    v_mov_b32 v229, 0
    v_mov_b32 v230, 0
    v_mov_b32 v231, 0
    v_mov_b32 v232, 0
    v_mov_b32 v233, 0
    v_mov_b32 v234, 0
    v_mov_b32 v235, 0
    v_mov_b32 v236, 0
    v_mov_b32 v237, 0
    v_mov_b32 v238, 0
    v_mov_b32 v239, 0
    v_mov_b32 v240, 0
    v_mov_b32 v241, 0
    v_mov_b32 v242, 0
    v_mov_b32 v243, 0
    v_mov_b32 v244, 0
    v_mov_b32 v245, 0
    v_mov_b32 v246, 0
    v_mov_b32 v247, 0
    v_mov_b32 v248, 0
    v_mov_b32 v249, 0
    v_mov_b32 v250, 0
    v_mov_b32 v251, 0
    v_mov_b32 v252, 0
    v_mov_b32 v253, 0
    v_mov_b32 v254, 0
    v_mov_b32 v255, 0
    v_bfe_u32 v15, v1, 2, 2
    v_lshl_add_u32 v15, v14, 3, v15
    v_bfe_u32 v16, v1, 4, 1
    v_lshl_add_u32 v15, v15, 1, v16
    v_and_b32_e64 v16, 3, v1
    v_lshl_add_u32 v15, v15, 2, v16
    s_lshr_b32 s7, s6, 2
    s_lshl_b32 s7, s7, 11
    s_add_u32 s7, s7, 159744
    v_lshl_add_u32 v27, v15, 3, s7
    s_getpc_b64 s[58:59]
PC0:
    s_lshl_b32 s7, s6, 13
    v_lshl_add_u32 v28, v1, 7, s7
    v_min_u32 v28, CODE_END-PC0-4, v28
    s_and_b32 s7, s6, 3
    s_lshl_b32 s7, s7, 1
    s_lshl_b32 s52, s4, 3
    s_add_u32 s52, s52, s7
    s_lshl_b32 s53, s51, 6
    s_add_u32 s53, s53, s52
    s_lshl_b32 s60, s5, 7
    s_lshl_b32 s7, s4, 2
    s_add_u32 s60, s60, s7
    s_xor_b32 s7, s3, 1
    s_lshl_b32 s7, s7, 11
    s_add_u32 s60, s60, s7
    s_add_u32 s60, s60, 20447232
    s_and_b32 s32, s2, 7
    s_lshl_b32 s32, s32, 2
    s_lshr_b32 s7, s2, 6
    s_add_u32 s32, s32, s7
    s_bfe_u32 s33, s2, 0x30003
    s_and_b32 s7, s6, 3
    s_lshl_b32 s7, s7, 1
    s_lshr_b32 s34, s6, 2
    s_add_u32 s34, s34, s7
    s_lshl_b32 s7, s33, 3
    s_add_u32 s34, s34, s7
    s_lshr_b32 s35, s32, 1
    s_lshl_b32 s35, s35, 7
    s_add_u32 s35, s35, 20447232
    s_mov_b32 s38, 0
    s_mov_b32 s36, 98304
    v_add_u32 v9, s38, v5
    v_add_u32 v10, s36, v7
    v_add_u32 v11, s36, v8
    s_add_u32 m0, 32768, s46
    s_add_u32 s67, s40, s65
    buffer_load_dwordx4 v2, s[8:11], s67 offen lds
    buffer_load_dwordx4 v3, s[8:11], s67 offen offset:1024 lds
    s_add_u32 m0, 32768, s47
    s_add_u32 s67, s41, s65
    buffer_load_dwordx4 v2, s[8:11], s67 offen lds
    buffer_load_dwordx4 v3, s[8:11], s67 offen offset:1024 lds
    s_add_u32 s62, s62, 128
    s_xor_b32 s65, s62, s63
    s_add_u32 m0, 122880, s44
    s_add_u32 s68, s42, s66
    buffer_load_dwordx4 v4, s[12:15], s68 offen lds
    s_cbranch_vccz SK_12
    s_add_u32 m0, 122880, s45
    s_add_u32 s68, s43, s66
    buffer_load_dwordx4 v4, s[12:15], s68 offen lds
SK_12:
    s_add_u32 s64, s64, 1
    s_xor_b32 s66, s64, s69
    s_mul_i32 s66, s66, 196608
    s_waitcnt vmcnt(7)
    s_lshl_b32 s7, s2, 3
    s_add_u32 s7, s7, s6
    s_cmp_lg_u32 s7, 7
    s_cbranch_scc1 NZ_13
    s_waitcnt vmcnt(0)
    v_mov_b32 v15, 1
    s_mov_b64 exec, 1
    buffer_store_dword v15, v224, s[20:23], 0 offen sc1
    s_mov_b64 exec, -1
NZ_13:
    s_barrier
    ds_read_b128 v[144:147], v9 offset:0
    ds_read_b64_tr_b16 v[160:161], v10 offset:0
    ds_read_b64_tr_b16 v[162:163], v10 offset:512
    ds_read_b128 v[148:151], v9 offset:2048
    ds_read_b64_tr_b16 v[164:165], v11 offset:0
    ds_read_b64_tr_b16 v[166:167], v11 offset:512
    ds_read_b128 v[152:155], v9 offset:4096
    ds_read_b64_tr_b16 v[168:169], v10 offset:4096
    ds_read_b64_tr_b16 v[170:171], v10 offset:4608
    ds_read_b128 v[156:159], v9 offset:6144
    ds_read_b64_tr_b16 v[172:173], v11 offset:4096
    ds_read_b64_tr_b16 v[174:175], v11 offset:4608
    ds_read_b64_tr_b16 v[176:177], v10 offset:8192
    ds_read_b64_tr_b16 v[178:179], v10 offset:8704
    ds_read_b64_tr_b16 v[180:181], v11 offset:8192
    ds_read_b64_tr_b16 v[182:183], v11 offset:8704
    s_add_u32 m0, 135168, s44
    s_add_u32 s68, s42, s66
    buffer_load_dwordx4 v4, s[12:15], s68 offen lds
    s_cbranch_vccnz SK_14
    s_add_u32 m0, 135168, s45
    s_add_u32 s68, s43, s66
    buffer_load_dwordx4 v4, s[12:15], s68 offen lds
SK_14:
    s_add_u32 s64, s64, 1
    s_xor_b32 s66, s64, s69
    s_nop 0
    s_mul_i32 s66, s66, 196608
    s_add_u32 s37, s36, 12288
    s_cmp_eq_u32 s37, 159744
    s_cselect_b32 s37, 98304, s37
    v_add_u32 v9, s38, v6
    v_add_u32 v10, s37, v7
    v_add_u32_e64 v11, s37, v8
    s_waitcnt vmcnt(7) lgkmcnt(0)
    s_barrier
    v_mfma_f32_16x16x32_bf16 v[48:51], v[160:163], v[144:147], 0
    ds_read_b128 v[184:187], v9 offset:0
    s_add_u32 m0, 65536, s46
    s_add_u32 s67, s40, s65
    s_nop 0
    buffer_load_dwordx4 v2, s[8:11], s67 offen lds
    v_mfma_f32_16x16x32_bf16 v[52:55], v[164:167], v[144:147], 0
    ds_read_b64_tr_b16 v[200:201], v10 offset:0
    buffer_load_dwordx4 v3, s[8:11], s67 offen offset:1024 lds
    v_mfma_f32_16x16x32_bf16 v[64:67], v[168:171], v[144:147], 0
    ds_read_b64_tr_b16 v[202:203], v10 offset:512
    s_add_u32 m0, 65536, s47
    s_add_u32 s67, s41, s65
    s_nop 0
    buffer_load_dwordx4 v2, s[8:11], s67 offen lds
    v_mfma_f32_16x16x32_bf16 v[68:71], v[172:175], v[144:147], 0
    ds_read_b128 v[188:191], v9 offset:2048
    buffer_load_dwordx4 v3, s[8:11], s67 offen offset:1024 lds
    s_add_u32 s62, s62, 128
    s_xor_b32 s65, s62, s63
    v_mfma_f32_16x16x32_bf16 v[80:83], v[144:147], v[176:179], 0
    ds_read_b64_tr_b16 v[204:205], v11 offset:0
    s_add_u32 m0, 147456, s44
    s_add_u32 s68, s42, s66
    buffer_load_dwordx4 v4, s[12:15], s68 offen lds
    v_mfma_f32_16x16x32_bf16 v[84:87], v[144:147], v[180:183], 0
    ds_read_b64_tr_b16 v[206:207], v11 offset:512
    s_cbranch_vccz SK_15
    s_add_u32 m0, 147456, s45
    s_add_u32 s68, s43, s66
    buffer_load_dwordx4 v4, s[12:15], s68 offen lds
SK_15:
    s_add_u32 s64, s64, 1
    s_xor_b32 s66, s64, s69
    s_mul_i32 s66, s66, 196608
    v_mfma_f32_16x16x32_bf16 v[92:95], v[148:151], v[180:183], 0
    ds_read_b128 v[192:195], v9 offset:4096
    v_mfma_f32_16x16x32_bf16 v[88:91], v[148:151], v[176:179], 0
    ds_read_b64_tr_b16 v[208:209], v10 offset:4096
    v_mfma_f32_16x16x32_bf16 v[76:79], v[172:175], v[148:151], 0
    ds_read_b64_tr_b16 v[210:211], v10 offset:4608
    v_mfma_f32_16x16x32_bf16 v[72:75], v[168:171], v[148:151], 0
    ds_read_b128 v[196:199], v9 offset:6144
    v_mfma_f32_16x16x32_bf16 v[60:63], v[164:167], v[148:151], 0
    ds_read_b64_tr_b16 v[212:213], v11 offset:4096
    v_mfma_f32_16x16x32_bf16 v[56:59], v[160:163], v[148:151], 0
    ds_read_b64_tr_b16 v[214:215], v11 offset:4608
    v_mfma_f32_16x16x32_bf16 v[96:99], v[160:163], v[152:155], 0
    ds_read_b64_tr_b16 v[216:217], v10 offset:8192
    v_mfma_f32_16x16x32_bf16 v[100:103], v[164:167], v[152:155], 0
    ds_read_b64_tr_b16 v[218:219], v10 offset:8704
    v_mfma_f32_16x16x32_bf16 v[112:115], v[168:171], v[152:155], 0
    ds_read_b64_tr_b16 v[220:221], v11 offset:8192
    v_mfma_f32_16x16x32_bf16 v[116:119], v[172:175], v[152:155], 0
    ds_read_b64_tr_b16 v[222:223], v11 offset:8704
    v_mfma_f32_16x16x32_bf16 v[128:131], v[152:155], v[176:179], 0
    s_add_u32 m0, s36, s44
    s_add_u32 s68, s42, s66
    buffer_load_dwordx4 v4, s[12:15], s68 offen lds
    v_mfma_f32_16x16x32_bf16 v[132:135], v[152:155], v[180:183], 0
    s_cbranch_vccnz SK_16
    s_add_u32 m0, s36, s45
    s_add_u32 s68, s43, s66
    buffer_load_dwordx4 v4, s[12:15], s68 offen lds
SK_16:
    s_add_u32 s64, s64, 1
    s_xor_b32 s66, s64, s69
    s_mul_i32 s66, s66, 196608
    v_mfma_f32_16x16x32_bf16 v[140:143], v[156:159], v[180:183], 0
    s_mov_b32 s39, s38
    s_mov_b32 s36, s37
    s_mov_b32 s38, s39
    s_add_u32 s37, s36, 12288
    s_cmp_eq_u32 s37, 159744
    s_cselect_b32 s37, 98304, s37
    s_add_u32 s39, s38, 32768
    s_cmp_eq_u32 s39, 98304
    s_cselect_b32 s39, 0, s39
    v_add_u32 v9, s39, v5
    v_add_u32 v10, s37, v7
    v_add_u32 v11, s37, v8
    v_mfma_f32_16x16x32_bf16 v[136:139], v[156:159], v[176:179], 0
    v_mfma_f32_16x16x32_bf16 v[124:127], v[172:175], v[156:159], 0
    v_mfma_f32_16x16x32_bf16 v[120:123], v[168:171], v[156:159], 0
    v_mfma_f32_16x16x32_bf16 v[108:111], v[164:167], v[156:159], 0
    v_mfma_f32_16x16x32_bf16 v[104:107], v[160:163], v[156:159], 0
    s_mov_b32 s48, 13
    s_cbranch_vccz G1HI_44
.p2align 6
G1LOOP_46:
    s_waitcnt vmcnt(8) lgkmcnt(0)
    s_barrier
    v_mfma_f32_16x16x32_bf16 v[48:51], v[200:203], v[184:187], v[48:51]
    ds_read_b128 v[144:147], v9 offset:0
    v_mfma_f32_16x16x32_bf16 v[52:55], v[204:207], v[184:187], v[52:55]
    ds_read_b64_tr_b16 v[160:161], v10 offset:0
    v_mfma_f32_16x16x32_bf16 v[64:67], v[208:211], v[184:187], v[64:67]
    ds_read_b64_tr_b16 v[162:163], v10 offset:512
    v_mfma_f32_16x16x32_bf16 v[68:71], v[212:215], v[184:187], v[68:71]
    ds_read_b128 v[148:151], v9 offset:2048
    v_mfma_f32_16x16x32_bf16 v[80:83], v[184:187], v[216:219], v[80:83]
    ds_read_b64_tr_b16 v[164:165], v11 offset:0
    v_mfma_f32_16x16x32_bf16 v[84:87], v[184:187], v[220:223], v[84:87]
    ds_read_b64_tr_b16 v[166:167], v11 offset:512
    v_mfma_f32_16x16x32_bf16 v[92:95], v[188:191], v[220:223], v[92:95]
    ds_read_b128 v[152:155], v9 offset:4096
    v_mfma_f32_16x16x32_bf16 v[88:91], v[188:191], v[216:219], v[88:91]
    ds_read_b64_tr_b16 v[168:169], v10 offset:4096
    v_mfma_f32_16x16x32_bf16 v[76:79], v[212:215], v[188:191], v[76:79]
    ds_read_b64_tr_b16 v[170:171], v10 offset:4608
    v_mfma_f32_16x16x32_bf16 v[72:75], v[208:211], v[188:191], v[72:75]
    ds_read_b128 v[156:159], v9 offset:6144
    v_mfma_f32_16x16x32_bf16 v[60:63], v[204:207], v[188:191], v[60:63]
    ds_read_b64_tr_b16 v[172:173], v11 offset:4096
    v_mfma_f32_16x16x32_bf16 v[56:59], v[200:203], v[188:191], v[56:59]
    ds_read_b64_tr_b16 v[174:175], v11 offset:4608
    v_mfma_f32_16x16x32_bf16 v[96:99], v[200:203], v[192:195], v[96:99]
    ds_read_b64_tr_b16 v[176:177], v10 offset:8192
    v_mfma_f32_16x16x32_bf16 v[100:103], v[204:207], v[192:195], v[100:103]
    ds_read_b64_tr_b16 v[178:179], v10 offset:8704
    v_mfma_f32_16x16x32_bf16 v[112:115], v[208:211], v[192:195], v[112:115]
    ds_read_b64_tr_b16 v[180:181], v11 offset:8192
    v_mfma_f32_16x16x32_bf16 v[116:119], v[212:215], v[192:195], v[116:119]
    ds_read_b64_tr_b16 v[182:183], v11 offset:8704
    v_mfma_f32_16x16x32_bf16 v[128:131], v[192:195], v[216:219], v[128:131]
    v_mfma_f32_16x16x32_bf16 v[132:135], v[192:195], v[220:223], v[132:135]
    v_mfma_f32_16x16x32_bf16 v[140:143], v[196:199], v[220:223], v[140:143]
    v_mfma_f32_16x16x32_bf16 v[136:139], v[196:199], v[216:219], v[136:139]
    v_mfma_f32_16x16x32_bf16 v[124:127], v[212:215], v[196:199], v[124:127]
    v_mfma_f32_16x16x32_bf16 v[120:123], v[208:211], v[196:199], v[120:123]
    v_mfma_f32_16x16x32_bf16 v[108:111], v[204:207], v[196:199], v[108:111]
    v_mfma_f32_16x16x32_bf16 v[104:107], v[200:203], v[196:199], v[104:107]
    s_add_u32 m0, s38, s46
    s_add_u32 s67, s40, s65
    buffer_load_dwordx4 v2, s[8:11], s67 offen lds
    buffer_load_dwordx4 v3, s[8:11], s67 offen offset:1024 lds
    s_add_u32 m0, s36, s44
    s_add_u32 s68, s42, s66
    buffer_load_dwordx4 v4, s[12:15], s68 offen lds
    s_add_u32 m0, s36, s45
    s_add_u32 s68, s43, s66
    buffer_load_dwordx4 v4, s[12:15], s68 offen lds
    s_add_u32 s64, s64, 1
    s_xor_b32 s66, s64, s69
    s_mul_i32 s66, s66, 196608
    s_mov_b32 s36, s37
    s_add_u32 s37, s36, 12288
    s_cmp_eq_u32 s37, 159744
    s_cselect_b32 s37, 98304, s37
    v_add_u32 v9, s39, v6
    v_add_u32 v10, s37, v7
    v_add_u32 v11, s37, v8
    s_waitcnt vmcnt(10) lgkmcnt(0)
    s_barrier
    v_mfma_f32_16x16x32_bf16 v[48:51], v[160:163], v[144:147], v[48:51]
    ds_read_b128 v[184:187], v9 offset:0
    v_mfma_f32_16x16x32_bf16 v[52:55], v[164:167], v[144:147], v[52:55]
    ds_read_b64_tr_b16 v[200:201], v10 offset:0
    v_mfma_f32_16x16x32_bf16 v[64:67], v[168:171], v[144:147], v[64:67]
    ds_read_b64_tr_b16 v[202:203], v10 offset:512
    v_mfma_f32_16x16x32_bf16 v[68:71], v[172:175], v[144:147], v[68:71]
    ds_read_b128 v[188:191], v9 offset:2048
    v_mfma_f32_16x16x32_bf16 v[80:83], v[144:147], v[176:179], v[80:83]
    ds_read_b64_tr_b16 v[204:205], v11 offset:0
    v_mfma_f32_16x16x32_bf16 v[84:87], v[144:147], v[180:183], v[84:87]
    ds_read_b64_tr_b16 v[206:207], v11 offset:512
    v_mfma_f32_16x16x32_bf16 v[92:95], v[148:151], v[180:183], v[92:95]
    ds_read_b128 v[192:195], v9 offset:4096
    v_mfma_f32_16x16x32_bf16 v[88:91], v[148:151], v[176:179], v[88:91]
    ds_read_b64_tr_b16 v[208:209], v10 offset:4096
    v_mfma_f32_16x16x32_bf16 v[76:79], v[172:175], v[148:151], v[76:79]
    ds_read_b64_tr_b16 v[210:211], v10 offset:4608
    v_mfma_f32_16x16x32_bf16 v[72:75], v[168:171], v[148:151], v[72:75]
    ds_read_b128 v[196:199], v9 offset:6144
    v_mfma_f32_16x16x32_bf16 v[60:63], v[164:167], v[148:151], v[60:63]
    ds_read_b64_tr_b16 v[212:213], v11 offset:4096
    v_mfma_f32_16x16x32_bf16 v[56:59], v[160:163], v[148:151], v[56:59]
    ds_read_b64_tr_b16 v[214:215], v11 offset:4608
    v_mfma_f32_16x16x32_bf16 v[96:99], v[160:163], v[152:155], v[96:99]
    ds_read_b64_tr_b16 v[216:217], v10 offset:8192
    v_mfma_f32_16x16x32_bf16 v[100:103], v[164:167], v[152:155], v[100:103]
    ds_read_b64_tr_b16 v[218:219], v10 offset:8704
    v_mfma_f32_16x16x32_bf16 v[112:115], v[168:171], v[152:155], v[112:115]
    ds_read_b64_tr_b16 v[220:221], v11 offset:8192
    v_mfma_f32_16x16x32_bf16 v[116:119], v[172:175], v[152:155], v[116:119]
    ds_read_b64_tr_b16 v[222:223], v11 offset:8704
    v_mfma_f32_16x16x32_bf16 v[128:131], v[152:155], v[176:179], v[128:131]
    v_mfma_f32_16x16x32_bf16 v[132:135], v[152:155], v[180:183], v[132:135]
    v_mfma_f32_16x16x32_bf16 v[140:143], v[156:159], v[180:183], v[140:143]
    v_mfma_f32_16x16x32_bf16 v[136:139], v[156:159], v[176:179], v[136:139]
    v_mfma_f32_16x16x32_bf16 v[124:127], v[172:175], v[156:159], v[124:127]
    v_mfma_f32_16x16x32_bf16 v[120:123], v[168:171], v[156:159], v[120:123]
    v_mfma_f32_16x16x32_bf16 v[108:111], v[164:167], v[156:159], v[108:111]
    v_mfma_f32_16x16x32_bf16 v[104:107], v[160:163], v[156:159], v[104:107]
    s_add_u32 m0, s38, s47
    s_add_u32 s67, s41, s65
    buffer_load_dwordx4 v2, s[8:11], s67 offen lds
    buffer_load_dwordx4 v3, s[8:11], s67 offen offset:1024 lds
    s_add_u32 s62, s62, 128
    s_xor_b32 s65, s62, s63
    s_add_u32 m0, s36, s44
    s_add_u32 s68, s42, s66
    buffer_load_dwordx4 v4, s[12:15], s68 offen lds
    s_add_u32 s64, s64, 1
    s_xor_b32 s66, s64, s69
    s_mul_i32 s66, s66, 196608
    s_mov_b32 s36, s37
    s_mov_b32 s38, s39
    s_nop 0
    s_add_u32 s37, s36, 12288
    s_cmp_eq_u32 s37, 159744
    s_cselect_b32 s37, 98304, s37
    s_add_u32 s39, s38, 32768
    s_cmp_eq_u32 s39, 98304
    s_cselect_b32 s39, 0, s39
    v_add_u32 v9, s39, v5
    v_add_u32 v10, s37, v7
    v_add_u32 v11, s37, v8
    s_sub_u32 s48, s48, 1
    s_cmp_lg_u32 s48, 0
    s_cbranch_scc1 G1LOOP_46
    s_waitcnt vmcnt(8) lgkmcnt(0)
    s_barrier
    s_branch G1JOIN_45
G1HI_44:
    s_waitcnt vmcnt(8) lgkmcnt(0)
    s_barrier
.p2align 6
G1LOOP_47:
    s_add_u32 m0, s38, s46
    s_add_u32 s67, s40, s65
    buffer_load_dwordx4 v2, s[8:11], s67 offen lds
    buffer_load_dwordx4 v3, s[8:11], s67 offen offset:1024 lds
    s_add_u32 m0, s36, s44
    s_add_u32 s68, s42, s66
    buffer_load_dwordx4 v4, s[12:15], s68 offen lds
    s_add_u32 s64, s64, 1
    s_xor_b32 s66, s64, s69
    s_mul_i32 s66, s66, 196608
    v_mfma_f32_16x16x32_bf16 v[48:51], v[200:203], v[184:187], v[48:51]
    ds_read_b128 v[144:147], v9 offset:0
    v_mfma_f32_16x16x32_bf16 v[52:55], v[204:207], v[184:187], v[52:55]
    ds_read_b64_tr_b16 v[160:161], v10 offset:0
    v_mfma_f32_16x16x32_bf16 v[64:67], v[208:211], v[184:187], v[64:67]
    ds_read_b64_tr_b16 v[162:163], v10 offset:512
    v_mfma_f32_16x16x32_bf16 v[68:71], v[212:215], v[184:187], v[68:71]
    ds_read_b128 v[148:151], v9 offset:2048
    v_mfma_f32_16x16x32_bf16 v[80:83], v[184:187], v[216:219], v[80:83]
    ds_read_b64_tr_b16 v[164:165], v11 offset:0
    v_mfma_f32_16x16x32_bf16 v[84:87], v[184:187], v[220:223], v[84:87]
    ds_read_b64_tr_b16 v[166:167], v11 offset:512
    v_mfma_f32_16x16x32_bf16 v[92:95], v[188:191], v[220:223], v[92:95]
    ds_read_b128 v[152:155], v9 offset:4096
    v_mfma_f32_16x16x32_bf16 v[88:91], v[188:191], v[216:219], v[88:91]
    ds_read_b64_tr_b16 v[168:169], v10 offset:4096
    v_mfma_f32_16x16x32_bf16 v[76:79], v[212:215], v[188:191], v[76:79]
    ds_read_b64_tr_b16 v[170:171], v10 offset:4608
    v_mfma_f32_16x16x32_bf16 v[72:75], v[208:211], v[188:191], v[72:75]
    ds_read_b128 v[156:159], v9 offset:6144
    v_mfma_f32_16x16x32_bf16 v[60:63], v[204:207], v[188:191], v[60:63]
    ds_read_b64_tr_b16 v[172:173], v11 offset:4096
    v_mfma_f32_16x16x32_bf16 v[56:59], v[200:203], v[188:191], v[56:59]
    ds_read_b64_tr_b16 v[174:175], v11 offset:4608
    v_mfma_f32_16x16x32_bf16 v[96:99], v[200:203], v[192:195], v[96:99]
    ds_read_b64_tr_b16 v[176:177], v10 offset:8192
    v_mfma_f32_16x16x32_bf16 v[100:103], v[204:207], v[192:195], v[100:103]
    ds_read_b64_tr_b16 v[178:179], v10 offset:8704
    v_mfma_f32_16x16x32_bf16 v[112:115], v[208:211], v[192:195], v[112:115]
    ds_read_b64_tr_b16 v[180:181], v11 offset:8192
    v_mfma_f32_16x16x32_bf16 v[116:119], v[212:215], v[192:195], v[116:119]
    ds_read_b64_tr_b16 v[182:183], v11 offset:8704
    v_mfma_f32_16x16x32_bf16 v[128:131], v[192:195], v[216:219], v[128:131]
    v_mfma_f32_16x16x32_bf16 v[132:135], v[192:195], v[220:223], v[132:135]
    v_mfma_f32_16x16x32_bf16 v[140:143], v[196:199], v[220:223], v[140:143]
    v_mfma_f32_16x16x32_bf16 v[136:139], v[196:199], v[216:219], v[136:139]
    v_mfma_f32_16x16x32_bf16 v[124:127], v[212:215], v[196:199], v[124:127]
    v_mfma_f32_16x16x32_bf16 v[120:123], v[208:211], v[196:199], v[120:123]
    v_mfma_f32_16x16x32_bf16 v[108:111], v[204:207], v[196:199], v[108:111]
    v_mfma_f32_16x16x32_bf16 v[104:107], v[200:203], v[196:199], v[104:107]
    s_waitcnt vmcnt(10) lgkmcnt(0)
    s_barrier
    s_mov_b32 s36, s37
    s_add_u32 s37, s36, 12288
    s_cmp_eq_u32 s37, 159744
    s_cselect_b32 s37, 98304, s37
    v_add_u32 v9, s39, v6
    v_add_u32 v10, s37, v7
    v_add_u32 v11, s37, v8
    s_add_u32 m0, s38, s47
    s_add_u32 s67, s41, s65
    buffer_load_dwordx4 v2, s[8:11], s67 offen lds
    buffer_load_dwordx4 v3, s[8:11], s67 offen offset:1024 lds
    s_add_u32 s62, s62, 128
    s_xor_b32 s65, s62, s63
    s_add_u32 m0, s36, s44
    s_add_u32 s68, s42, s66
    buffer_load_dwordx4 v4, s[12:15], s68 offen lds
    s_add_u32 m0, s36, s45
    s_add_u32 s68, s43, s66
    buffer_load_dwordx4 v4, s[12:15], s68 offen lds
    s_add_u32 s64, s64, 1
    s_xor_b32 s66, s64, s69
    s_nop 0
    s_mul_i32 s66, s66, 196608
    v_mfma_f32_16x16x32_bf16 v[48:51], v[160:163], v[144:147], v[48:51]
    ds_read_b128 v[184:187], v9 offset:0
    v_mfma_f32_16x16x32_bf16 v[52:55], v[164:167], v[144:147], v[52:55]
    ds_read_b64_tr_b16 v[200:201], v10 offset:0
    v_mfma_f32_16x16x32_bf16 v[64:67], v[168:171], v[144:147], v[64:67]
    ds_read_b64_tr_b16 v[202:203], v10 offset:512
    v_mfma_f32_16x16x32_bf16 v[68:71], v[172:175], v[144:147], v[68:71]
    ds_read_b128 v[188:191], v9 offset:2048
    v_mfma_f32_16x16x32_bf16 v[80:83], v[144:147], v[176:179], v[80:83]
    ds_read_b64_tr_b16 v[204:205], v11 offset:0
    v_mfma_f32_16x16x32_bf16 v[84:87], v[144:147], v[180:183], v[84:87]
    ds_read_b64_tr_b16 v[206:207], v11 offset:512
    v_mfma_f32_16x16x32_bf16 v[92:95], v[148:151], v[180:183], v[92:95]
    ds_read_b128 v[192:195], v9 offset:4096
    v_mfma_f32_16x16x32_bf16 v[88:91], v[148:151], v[176:179], v[88:91]
    ds_read_b64_tr_b16 v[208:209], v10 offset:4096
    v_mfma_f32_16x16x32_bf16 v[76:79], v[172:175], v[148:151], v[76:79]
    ds_read_b64_tr_b16 v[210:211], v10 offset:4608
    v_mfma_f32_16x16x32_bf16 v[72:75], v[168:171], v[148:151], v[72:75]
    ds_read_b128 v[196:199], v9 offset:6144
    v_mfma_f32_16x16x32_bf16 v[60:63], v[164:167], v[148:151], v[60:63]
    ds_read_b64_tr_b16 v[212:213], v11 offset:4096
    v_mfma_f32_16x16x32_bf16 v[56:59], v[160:163], v[148:151], v[56:59]
    ds_read_b64_tr_b16 v[214:215], v11 offset:4608
    v_mfma_f32_16x16x32_bf16 v[96:99], v[160:163], v[152:155], v[96:99]
    ds_read_b64_tr_b16 v[216:217], v10 offset:8192
    v_mfma_f32_16x16x32_bf16 v[100:103], v[164:167], v[152:155], v[100:103]
    ds_read_b64_tr_b16 v[218:219], v10 offset:8704
    v_mfma_f32_16x16x32_bf16 v[112:115], v[168:171], v[152:155], v[112:115]
    ds_read_b64_tr_b16 v[220:221], v11 offset:8192
    v_mfma_f32_16x16x32_bf16 v[116:119], v[172:175], v[152:155], v[116:119]
    ds_read_b64_tr_b16 v[222:223], v11 offset:8704
    v_mfma_f32_16x16x32_bf16 v[128:131], v[152:155], v[176:179], v[128:131]
    v_mfma_f32_16x16x32_bf16 v[132:135], v[152:155], v[180:183], v[132:135]
    v_mfma_f32_16x16x32_bf16 v[140:143], v[156:159], v[180:183], v[140:143]
    v_mfma_f32_16x16x32_bf16 v[136:139], v[156:159], v[176:179], v[136:139]
    v_mfma_f32_16x16x32_bf16 v[124:127], v[172:175], v[156:159], v[124:127]
    v_mfma_f32_16x16x32_bf16 v[120:123], v[168:171], v[156:159], v[120:123]
    v_mfma_f32_16x16x32_bf16 v[108:111], v[164:167], v[156:159], v[108:111]
    v_mfma_f32_16x16x32_bf16 v[104:107], v[160:163], v[156:159], v[104:107]
    s_waitcnt vmcnt(8) lgkmcnt(0)
    s_barrier
    s_mov_b32 s36, s37
    s_mov_b32 s38, s39
    s_add_u32 s37, s36, 12288
    s_cmp_eq_u32 s37, 159744
    s_cselect_b32 s37, 98304, s37
    s_add_u32 s39, s38, 32768
    s_cmp_eq_u32 s39, 98304
    s_cselect_b32 s39, 0, s39
    v_add_u32 v9, s39, v5
    v_add_u32_e64 v10, s37, v7
    v_add_u32 v11, s37, v8
    s_sub_u32 s48, s48, 1
    s_cmp_lg_u32 s48, 0
    s_cbranch_scc1 G1LOOP_47
G1JOIN_45:
    v_mfma_f32_16x16x32_bf16 v[48:51], v[200:203], v[184:187], v[48:51]
    ds_read_b128 v[144:147], v9 offset:0
    v_mfma_f32_16x16x32_bf16 v[52:55], v[204:207], v[184:187], v[52:55]
    ds_read_b64_tr_b16 v[160:161], v10 offset:0
    v_mfma_f32_16x16x32_bf16 v[64:67], v[208:211], v[184:187], v[64:67]
    ds_read_b64_tr_b16 v[162:163], v10 offset:512
    v_mfma_f32_16x16x32_bf16 v[68:71], v[212:215], v[184:187], v[68:71]
    ds_read_b128 v[148:151], v9 offset:2048
    v_mfma_f32_16x16x32_bf16 v[80:83], v[184:187], v[216:219], v[80:83]
    ds_read_b64_tr_b16 v[164:165], v11 offset:0
    v_mfma_f32_16x16x32_bf16 v[84:87], v[184:187], v[220:223], v[84:87]
    ds_read_b64_tr_b16 v[166:167], v11 offset:512
    v_mfma_f32_16x16x32_bf16 v[92:95], v[188:191], v[220:223], v[92:95]
    ds_read_b128 v[152:155], v9 offset:4096
    v_mfma_f32_16x16x32_bf16 v[88:91], v[188:191], v[216:219], v[88:91]
    ds_read_b64_tr_b16 v[168:169], v10 offset:4096
    v_mfma_f32_16x16x32_bf16 v[76:79], v[212:215], v[188:191], v[76:79]
    ds_read_b64_tr_b16 v[170:171], v10 offset:4608
    v_mfma_f32_16x16x32_bf16 v[72:75], v[208:211], v[188:191], v[72:75]
    ds_read_b128 v[156:159], v9 offset:6144
    v_mfma_f32_16x16x32_bf16 v[60:63], v[204:207], v[188:191], v[60:63]
    ds_read_b64_tr_b16 v[172:173], v11 offset:4096
    v_mfma_f32_16x16x32_bf16 v[56:59], v[200:203], v[188:191], v[56:59]
    ds_read_b64_tr_b16 v[174:175], v11 offset:4608
    v_mfma_f32_16x16x32_bf16 v[96:99], v[200:203], v[192:195], v[96:99]
    ds_read_b64_tr_b16 v[176:177], v10 offset:8192
    v_mfma_f32_16x16x32_bf16 v[100:103], v[204:207], v[192:195], v[100:103]
    ds_read_b64_tr_b16 v[178:179], v10 offset:8704
    v_mfma_f32_16x16x32_bf16 v[112:115], v[208:211], v[192:195], v[112:115]
    ds_read_b64_tr_b16 v[180:181], v11 offset:8192
    v_mfma_f32_16x16x32_bf16 v[116:119], v[212:215], v[192:195], v[116:119]
    ds_read_b64_tr_b16 v[182:183], v11 offset:8704
    v_mfma_f32_16x16x32_bf16 v[128:131], v[192:195], v[216:219], v[128:131]
    global_load_dword v12, v28, s[58:59]
    v_mfma_f32_16x16x32_bf16 v[132:135], v[192:195], v[220:223], v[132:135]
    s_mov_b32 s36, s37
    s_add_u32 s37, s36, 12288
    s_cmp_eq_u32 s37, 159744
    s_cselect_b32 s37, 98304, s37
    v_add_u32 v9, s39, v6
    v_add_u32 v10, s37, v7
    v_add_u32 v11, s37, v8
    v_mfma_f32_16x16x32_bf16 v[140:143], v[196:199], v[220:223], v[140:143]
    v_mfma_f32_16x16x32_bf16 v[136:139], v[196:199], v[216:219], v[136:139]
    v_mfma_f32_16x16x32_bf16 v[124:127], v[212:215], v[196:199], v[124:127]
    v_mfma_f32_16x16x32_bf16 v[120:123], v[208:211], v[196:199], v[120:123]
    v_mfma_f32_16x16x32_bf16 v[108:111], v[204:207], v[196:199], v[108:111]
    v_mfma_f32_16x16x32_bf16 v[104:107], v[200:203], v[196:199], v[104:107]
    s_cmp_eq_u32 s3, 0
    s_cbranch_scc1 TAILA_49
    s_waitcnt vmcnt(8) lgkmcnt(0)
    s_barrier
    v_mfma_f32_16x16x32_bf16 v[64:67], v[168:171], v[144:147], v[64:67]
    ds_read_b128 v[184:187], v9 offset:0
    v_mfma_f32_16x16x32_bf16 v[68:71], v[172:175], v[144:147], v[68:71]
    ds_read_b64_tr_b16 v[208:209], v10 offset:4096
    v_mfma_f32_16x16x32_bf16 v[80:83], v[144:147], v[176:179], v[80:83]
    ds_read_b64_tr_b16 v[210:211], v10 offset:4608
    v_mfma_f32_16x16x32_bf16 v[84:87], v[144:147], v[180:183], v[84:87]
    ds_read_b128 v[188:191], v9 offset:2048
    v_mfma_f32_16x16x32_bf16 v[92:95], v[148:151], v[180:183], v[92:95]
    ds_read_b64_tr_b16 v[212:213], v11 offset:4096
    v_mfma_f32_16x16x32_bf16 v[88:91], v[148:151], v[176:179], v[88:91]
    ds_read_b64_tr_b16 v[214:215], v11 offset:4608
    v_mfma_f32_16x16x32_bf16 v[76:79], v[172:175], v[148:151], v[76:79]
    ds_read_b128 v[192:195], v9 offset:4096
    v_mfma_f32_16x16x32_bf16 v[72:75], v[168:171], v[148:151], v[72:75]
    ds_read_b64_tr_b16 v[216:217], v10 offset:8192
    v_mfma_f32_16x16x32_bf16 v[112:115], v[168:171], v[152:155], v[112:115]
    ds_read_b64_tr_b16 v[218:219], v10 offset:8704
    v_mfma_f32_16x16x32_bf16 v[116:119], v[172:175], v[152:155], v[116:119]
    ds_read_b128 v[196:199], v9 offset:6144
    v_mfma_f32_16x16x32_bf16 v[128:131], v[152:155], v[176:179], v[128:131]
    ds_read_b64_tr_b16 v[220:221], v11 offset:8192
    v_mfma_f32_16x16x32_bf16 v[132:135], v[152:155], v[180:183], v[132:135]
    ds_read_b64_tr_b16 v[222:223], v11 offset:8704
    v_mfma_f32_16x16x32_bf16 v[140:143], v[156:159], v[180:183], v[140:143]
    s_mov_b32 s36, s37
    s_mov_b32 s38, s39
    s_add_u32 s37, s36, 12288
    s_cmp_eq_u32 s37, 159744
    s_cselect_b32 s37, 98304, s37
    s_add_u32 s39, s38, 32768
    s_cmp_eq_u32 s39, 98304
    s_cselect_b32 s39, 0, s39
    v_add_u32 v9, s39, v5
    v_add_u32 v10, s37, v7
    v_add_u32 v11, s37, v8
    v_mfma_f32_16x16x32_bf16 v[136:139], v[156:159], v[176:179], v[136:139]
    v_mfma_f32_16x16x32_bf16 v[124:127], v[172:175], v[156:159], v[124:127]
    v_mfma_f32_16x16x32_bf16 v[120:123], v[168:171], v[156:159], v[120:123]
    s_waitcnt vmcnt(2) lgkmcnt(0)
    s_barrier
    v_mfma_f32_16x16x32_bf16 v[64:67], v[208:211], v[184:187], v[64:67]
    ds_read_b128 v[144:147], v9 offset:0
    v_mfma_f32_16x16x32_bf16 v[68:71], v[212:215], v[184:187], v[68:71]
    ds_read_b64_tr_b16 v[168:169], v10 offset:4096
    v_mfma_f32_16x16x32_bf16 v[80:83], v[184:187], v[216:219], v[80:83]
    ds_read_b64_tr_b16 v[170:171], v10 offset:4608
    v_mfma_f32_16x16x32_bf16 v[84:87], v[184:187], v[220:223], v[84:87]
    ds_read_b128 v[148:151], v9 offset:2048
    v_mfma_f32_16x16x32_bf16 v[92:95], v[188:191], v[220:223], v[92:95]
    ds_read_b64_tr_b16 v[172:173], v11 offset:4096
    v_mfma_f32_16x16x32_bf16 v[88:91], v[188:191], v[216:219], v[88:91]
    ds_read_b64_tr_b16 v[174:175], v11 offset:4608
    v_mfma_f32_16x16x32_bf16 v[76:79], v[212:215], v[188:191], v[76:79]
    ds_read_b128 v[152:155], v9 offset:4096
    v_mfma_f32_16x16x32_bf16 v[72:75], v[208:211], v[188:191], v[72:75]
    ds_read_b64_tr_b16 v[176:177], v10 offset:8192
    v_mfma_f32_16x16x32_bf16 v[112:115], v[208:211], v[192:195], v[112:115]
    ds_read_b64_tr_b16 v[178:179], v10 offset:8704
    v_mfma_f32_16x16x32_bf16 v[116:119], v[212:215], v[192:195], v[116:119]
    ds_read_b128 v[156:159], v9 offset:6144
    v_mfma_f32_16x16x32_bf16 v[128:131], v[192:195], v[216:219], v[128:131]
    ds_read_b64_tr_b16 v[180:181], v11 offset:8192
    v_mfma_f32_16x16x32_bf16 v[132:135], v[192:195], v[220:223], v[132:135]
    ds_read_b64_tr_b16 v[182:183], v11 offset:8704
    v_mfma_f32_16x16x32_bf16 v[140:143], v[196:199], v[220:223], v[140:143]
    s_mov_b32 s36, s37
    s_add_u32 s37, s36, 12288
    s_cmp_eq_u32 s37, 159744
    s_cselect_b32 s37, 98304, s37
    v_add_u32 v9, s39, v6
    v_add_u32 v10, s37, v7
    v_add_u32 v11, s37, v8
    v_mfma_f32_16x16x32_bf16 v[136:139], v[196:199], v[216:219], v[136:139]
    v_mfma_f32_16x16x32_bf16 v[124:127], v[212:215], v[196:199], v[124:127]
    v_mfma_f32_16x16x32_bf16 v[120:123], v[208:211], v[196:199], v[120:123]
    s_waitcnt vmcnt(1) lgkmcnt(0)
    s_barrier
    v_mfma_f32_16x16x32_bf16 v[64:67], v[168:171], v[144:147], v[64:67]
    ds_read_b128 v[184:187], v9 offset:0
    v_mfma_f32_16x16x32_bf16 v[68:71], v[172:175], v[144:147], v[68:71]
    ds_read_b64_tr_b16 v[208:209], v10 offset:4096
    v_mfma_f32_16x16x32_bf16 v[80:83], v[144:147], v[176:179], v[80:83]
    ds_read_b64_tr_b16 v[210:211], v10 offset:4608
    v_mfma_f32_16x16x32_bf16 v[84:87], v[144:147], v[180:183], v[84:87]
    ds_read_b128 v[188:191], v9 offset:2048
    v_mfma_f32_16x16x32_bf16 v[92:95], v[148:151], v[180:183], v[92:95]
    ds_read_b64_tr_b16 v[212:213], v11 offset:4096
    v_mfma_f32_16x16x32_bf16 v[88:91], v[148:151], v[176:179], v[88:91]
    ds_read_b64_tr_b16 v[214:215], v11 offset:4608
    v_mfma_f32_16x16x32_bf16 v[76:79], v[172:175], v[148:151], v[76:79]
    ds_read_b128 v[192:195], v9 offset:4096
    v_mfma_f32_16x16x32_bf16 v[72:75], v[168:171], v[148:151], v[72:75]
    ds_read_b64_tr_b16 v[216:217], v10 offset:8192
    v_mfma_f32_16x16x32_bf16 v[112:115], v[168:171], v[152:155], v[112:115]
    ds_read_b64_tr_b16 v[218:219], v10 offset:8704
    v_mfma_f32_16x16x32_bf16 v[116:119], v[172:175], v[152:155], v[116:119]
    ds_read_b128 v[196:199], v9 offset:6144
    v_mfma_f32_16x16x32_bf16 v[128:131], v[152:155], v[176:179], v[128:131]
    ds_read_b64_tr_b16 v[220:221], v11 offset:8192
    v_mfma_f32_16x16x32_bf16 v[132:135], v[152:155], v[180:183], v[132:135]
    ds_read_b64_tr_b16 v[222:223], v11 offset:8704
    v_mfma_f32_16x16x32_bf16 v[140:143], v[156:159], v[180:183], v[140:143]
    s_cmp_lg_u32 s6, 0
    s_cbranch_scc1 NI_43
    buffer_load_dword v13, v224, s[20:23], 0 offen sc1
NI_43:
    v_mfma_f32_16x16x32_bf16 v[136:139], v[156:159], v[176:179], v[136:139]
    s_mov_b32 s36, s37
    s_mov_b32 s38, s39
    s_add_u32 s37, s36, 12288
    s_cmp_eq_u32 s37, 159744
    s_cselect_b32 s37, 98304, s37
    s_add_u32 s39, s38, 32768
    s_cmp_eq_u32 s39, 98304
    s_cselect_b32 s39, 0, s39
    v_mfma_f32_16x16x32_bf16 v[124:127], v[172:175], v[156:159], v[124:127]
    v_mfma_f32_16x16x32_bf16 v[120:123], v[168:171], v[156:159], v[120:123]
    s_waitcnt vmcnt(63) lgkmcnt(0)
    s_barrier
    s_nop 0
    v_mfma_f32_16x16x32_bf16 v[64:67], v[208:211], v[184:187], v[64:67]
    v_add_u32 v9, 65536, v5
    v_add_u32 v10, 135168, v7
    v_add_u32 v11, 135168, v8
    v_mfma_f32_16x16x32_bf16 v[68:71], v[212:215], v[184:187], v[68:71]
    ds_read_b128 v[144:147], v9 offset:0
    v_mfma_f32_16x16x32_bf16 v[80:83], v[184:187], v[216:219], v[80:83]
    ds_read_b64_tr_b16 v[160:161], v10 offset:0
    v_mfma_f32_16x16x32_bf16 v[84:87], v[184:187], v[220:223], v[84:87]
    ds_read_b64_tr_b16 v[162:163], v10 offset:512
    v_mfma_f32_16x16x32_bf16 v[92:95], v[188:191], v[220:223], v[92:95]
    ds_read_b128 v[148:151], v9 offset:2048
    v_mfma_f32_16x16x32_bf16 v[88:91], v[188:191], v[216:219], v[88:91]
    ds_read_b64_tr_b16 v[164:165], v11 offset:0
    v_mfma_f32_16x16x32_bf16 v[76:79], v[212:215], v[188:191], v[76:79]
    ds_read_b64_tr_b16 v[166:167], v11 offset:512
    v_mfma_f32_16x16x32_bf16 v[72:75], v[208:211], v[188:191], v[72:75]
    ds_read_b128 v[152:155], v9 offset:4096
    v_mfma_f32_16x16x32_bf16 v[112:115], v[208:211], v[192:195], v[112:115]
    ds_read_b128 v[156:159], v9 offset:6144
    v_mfma_f32_16x16x32_bf16 v[116:119], v[212:215], v[192:195], v[116:119]
    v_mfma_f32_16x16x32_bf16 v[128:131], v[192:195], v[216:219], v[128:131]
    v_mfma_f32_16x16x32_bf16 v[132:135], v[192:195], v[220:223], v[132:135]
    v_mfma_f32_16x16x32_bf16 v[140:143], v[196:199], v[220:223], v[140:143]
    v_mfma_f32_16x16x32_bf16 v[136:139], v[196:199], v[216:219], v[136:139]
    v_mfma_f32_16x16x32_bf16 v[124:127], v[212:215], v[196:199], v[124:127]
    v_mfma_f32_16x16x32_bf16 v[120:123], v[208:211], v[196:199], v[120:123]
    v_lshlrev_b32_e64 v2, 4, v1
    s_lshl_b32 s43, s32, 6
    s_add_u32 s43, s43, s34
    s_lshl_b32 s43, s43, 11
    s_lshl_b32 s41, s32, 18
    s_add_u32 s41, s41, 4194304
    s_lshl_b32 s44, s6, 12
    s_add_u32 s40, s41, s44
    s_lshr_b32 s45, s6, 2
    s_add_u32 s46, s43, 0
    s_xor_b32 s47, s46, 2048
    s_lshl_b32 s54, s53, 11
    s_add_u32 s54, s54, 0
    s_lshl_b32 s55, s53, 12
    s_add_u32 s55, s55, 4194304
    s_add_u32 s56, s55, 4096
    s_mov_b32 s58, 0x3e8293ee
    s_mov_b32 s59, s58
    v_cvt_pk_bf16_f32 v216, v64, v65
    v_cvt_pk_bf16_f32 v217, v66, v67
    v_cvt_pk_bf16_f32 v218, v68, v69
    v_cvt_pk_bf16_f32 v219, v70, v71
    v_cvt_pk_bf16_f32 v220, v72, v73
    v_cvt_pk_bf16_f32 v221, v74, v75
    v_cvt_pk_bf16_f32 v222, v76, v77
    v_cvt_pk_bf16_f32 v223, v78, v79
    s_nop 1
    v_permlane16_swap_b32 v216, v220
    v_permlane16_swap_b32 v217, v221
    v_permlane16_swap_b32 v218, v222
    v_permlane16_swap_b32_e64 v219, v223
    buffer_store_dwordx4 v[216:219], v2, s[16:19], s55 offen offset:0 sc1
    buffer_store_dwordx4 v[220:223], v2, s[16:19], s55 offen offset:1024 sc1
    s_waitcnt lgkmcnt(0)
    s_nop 0
    v_add_u32 v9, 65536, v6
    v_add_u32 v10, 147456, v7
    v_add_u32 v11, 147456, v8
    v_mfma_f32_16x16x32_bf16 v[48:51], v[160:163], v[144:147], v[48:51]
    ds_read_b128 v[184:187], v9 offset:0
    v_mfma_f32_16x16x32_bf16 v[52:55], v[164:167], v[144:147], v[52:55]
    ds_read_b64_tr_b16 v[200:201], v10 offset:0
    v_mfma_f32_16x16x32_bf16 v[60:63], v[164:167], v[148:151], v[60:63]
    ds_read_b64_tr_b16 v[202:203], v10 offset:512
    v_mfma_f32_16x16x32_bf16 v[56:59], v[160:163], v[148:151], v[56:59]
    ds_read_b128 v[188:191], v9 offset:2048
    v_mfma_f32_16x16x32_bf16 v[96:99], v[160:163], v[152:155], v[96:99]
    ds_read_b64_tr_b16 v[204:205], v11 offset:0
    v_mfma_f32_16x16x32_bf16 v[100:103], v[164:167], v[152:155], v[100:103]
    ds_read_b64_tr_b16 v[206:207], v11 offset:512
    v_mfma_f32_16x16x32_bf16 v[108:111], v[164:167], v[156:159], v[108:111]
    ds_read_b128 v[192:195], v9 offset:4096
    v_mfma_f32_16x16x32_bf16 v[104:107], v[160:163], v[156:159], v[104:107]
    ds_read_b128 v[196:199], v9 offset:6144
    v_cvt_pk_bf16_f32 v224, v80, v81
    v_cvt_pk_bf16_f32 v225, v82, v83
    v_cvt_pk_bf16_f32 v226, v84, v85
    v_cvt_pk_bf16_f32 v227, v86, v87
    v_cvt_pk_bf16_f32 v228, v88, v89
    v_cvt_pk_bf16_f32 v229, v90, v91
    v_cvt_pk_bf16_f32 v230, v92, v93
    v_cvt_pk_bf16_f32 v231, v94, v95
    s_nop 1
    v_permlane16_swap_b32 v224, v226
    v_permlane16_swap_b32 v225, v227
    v_permlane16_swap_b32 v228, v230
    v_permlane16_swap_b32_e64 v229, v231
    buffer_store_dwordx4 v[224:227], v2, s[16:19], s55 offen offset:2048 sc1
    buffer_store_dwordx4 v[228:231], v2, s[16:19], s55 offen offset:3072 sc1
    s_waitcnt lgkmcnt(0)
    v_add_u32 v9, 0, v5
    v_add_u32 v10, 98304, v7
    v_add_u32 v11, 98304, v8
    v_mfma_f32_16x16x32_bf16 v[48:51], v[200:203], v[184:187], v[48:51]
    ds_read_b128 v[144:147], v9 offset:0
    v_mfma_f32_16x16x32_bf16 v[52:55], v[204:207], v[184:187], v[52:55]
    ds_read_b64_tr_b16 v[160:161], v10 offset:0
    v_mfma_f32_16x16x32_bf16 v[60:63], v[204:207], v[188:191], v[60:63]
    ds_read_b64_tr_b16 v[162:163], v10 offset:512
    v_mfma_f32_16x16x32_bf16 v[56:59], v[200:203], v[188:191], v[56:59]
    ds_read_b128 v[148:151], v9 offset:2048
    v_mfma_f32_16x16x32_bf16 v[96:99], v[200:203], v[192:195], v[96:99]
    ds_read_b64_tr_b16 v[164:165], v11 offset:0
    v_mfma_f32_16x16x32_bf16 v[100:103], v[204:207], v[192:195], v[100:103]
    ds_read_b64_tr_b16 v[166:167], v11 offset:512
    v_mfma_f32_16x16x32_bf16 v[108:111], v[204:207], v[196:199], v[108:111]
    ds_read_b128 v[152:155], v9 offset:4096
    v_mfma_f32_16x16x32_bf16 v[104:107], v[200:203], v[196:199], v[104:107]
    ds_read_b128 v[156:159], v9 offset:6144
    v_cvt_pk_bf16_f32 v240, v112, v113
    v_cvt_pk_bf16_f32 v241, v114, v115
    v_cvt_pk_bf16_f32 v242, v116, v117
    v_cvt_pk_bf16_f32 v243, v118, v119
    v_cvt_pk_bf16_f32 v244, v120, v121
    v_cvt_pk_bf16_f32 v245, v122, v123
    v_cvt_pk_bf16_f32 v246, v124, v125
    v_cvt_pk_bf16_f32 v247, v126, v127
    s_nop 1
    v_permlane16_swap_b32 v240, v244
    v_permlane16_swap_b32 v241, v245
    v_permlane16_swap_b32 v242, v246
    v_permlane16_swap_b32_e64 v243, v247
    buffer_store_dwordx4 v[240:243], v2, s[16:19], s56 offen offset:0 sc1
    buffer_store_dwordx4 v[244:247], v2, s[16:19], s56 offen offset:1024 sc1
    s_waitcnt lgkmcnt(0)
    v_add_u32 v9, 0, v6
    v_add_u32 v10, 110592, v7
    v_add_u32 v11, 110592, v8
    v_mfma_f32_16x16x32_bf16 v[48:51], v[160:163], v[144:147], v[48:51]
    ds_read_b128 v[184:187], v9 offset:0
    v_mfma_f32_16x16x32_bf16 v[52:55], v[164:167], v[144:147], v[52:55]
    ds_read_b64_tr_b16 v[200:201], v10 offset:0
    v_mfma_f32_16x16x32_bf16 v[60:63], v[164:167], v[148:151], v[60:63]
    ds_read_b64_tr_b16 v[202:203], v10 offset:512
    v_mfma_f32_16x16x32_bf16 v[56:59], v[160:163], v[148:151], v[56:59]
    ds_read_b128 v[188:191], v9 offset:2048
    v_mfma_f32_16x16x32_bf16 v[96:99], v[160:163], v[152:155], v[96:99]
    ds_read_b64_tr_b16 v[204:205], v11 offset:0
    v_mfma_f32_16x16x32_bf16 v[100:103], v[164:167], v[152:155], v[100:103]
    ds_read_b64_tr_b16 v[206:207], v11 offset:512
    v_mfma_f32_16x16x32_bf16 v[108:111], v[164:167], v[156:159], v[108:111]
    ds_read_b128 v[192:195], v9 offset:4096
    v_mfma_f32_16x16x32_bf16 v[104:107], v[160:163], v[156:159], v[104:107]
    ds_read_b128 v[196:199], v9 offset:6144
    v_cvt_pk_bf16_f32 v248, v128, v129
    v_cvt_pk_bf16_f32 v249, v130, v131
    v_cvt_pk_bf16_f32 v250, v132, v133
    v_cvt_pk_bf16_f32 v251, v134, v135
    v_cvt_pk_bf16_f32 v252, v136, v137
    v_cvt_pk_bf16_f32 v253, v138, v139
    v_cvt_pk_bf16_f32 v254, v140, v141
    v_cvt_pk_bf16_f32 v255, v142, v143
    s_nop 1
    v_permlane16_swap_b32 v248, v250
    v_permlane16_swap_b32 v249, v251
    v_permlane16_swap_b32 v252, v254
    v_permlane16_swap_b32_e64 v253, v255
    buffer_store_dwordx4 v[248:251], v2, s[16:19], s56 offen offset:2048 sc1
    buffer_store_dwordx4 v[252:255], v2, s[16:19], s56 offen offset:3072 sc1
    s_waitcnt lgkmcnt(0)
    s_nop 0
    v_mfma_f32_16x16x32_bf16 v[48:51], v[200:203], v[184:187], v[48:51]
    v_mfma_f32_16x16x32_bf16 v[52:55], v[204:207], v[184:187], v[52:55]
    v_mfma_f32_16x16x32_bf16 v[60:63], v[204:207], v[188:191], v[60:63]
    v_mfma_f32_16x16x32_bf16 v[56:59], v[200:203], v[188:191], v[56:59]
    v_mfma_f32_16x16x32_bf16 v[96:99], v[200:203], v[192:195], v[96:99]
    v_mfma_f32_16x16x32_bf16 v[100:103], v[204:207], v[192:195], v[100:103]
    v_mfma_f32_16x16x32_bf16 v[108:111], v[204:207], v[196:199], v[108:111]
    v_mfma_f32_16x16x32_bf16 v[104:107], v[200:203], v[196:199], v[104:107]
    s_nop 7
    s_nop 0
    v_pk_mul_f32 v[48:49], v[48:49], s[58:59]
    v_pk_mul_f32 v[50:51], v[50:51], s[58:59]
    v_pk_mul_f32 v[52:53], v[52:53], s[58:59]
    v_pk_mul_f32 v[54:55], v[54:55], s[58:59]
    v_pk_mul_f32 v[56:57], v[56:57], s[58:59]
    v_pk_mul_f32 v[58:59], v[58:59], s[58:59]
    v_pk_mul_f32 v[60:61], v[60:61], s[58:59]
    v_pk_mul_f32 v[62:63], v[62:63], s[58:59]
    v_cvt_pk_bf16_f32 v208, v48, v49
    v_cvt_pk_bf16_f32 v209, v50, v51
    v_cvt_pk_bf16_f32 v210, v52, v53
    v_cvt_pk_bf16_f32 v211, v54, v55
    v_cvt_pk_bf16_f32 v212, v56, v57
    v_cvt_pk_bf16_f32 v213, v58, v59
    v_cvt_pk_bf16_f32 v214, v60, v61
    v_cvt_pk_bf16_f32 v215, v62, v63
    v_pk_mul_f32 v[96:97], v[96:97], s[58:59]
    v_pk_mul_f32 v[98:99], v[98:99], s[58:59]
    v_pk_mul_f32 v[100:101], v[100:101], s[58:59]
    v_pk_mul_f32 v[102:103], v[102:103], s[58:59]
    v_pk_mul_f32 v[104:105], v[104:105], s[58:59]
    v_pk_mul_f32 v[106:107], v[106:107], s[58:59]
    v_pk_mul_f32 v[108:109], v[108:109], s[58:59]
    v_pk_mul_f32 v[110:111], v[110:111], s[58:59]
    v_cvt_pk_bf16_f32 v232, v96, v97
    v_cvt_pk_bf16_f32 v233, v98, v99
    v_cvt_pk_bf16_f32 v234, v100, v101
    v_cvt_pk_bf16_f32 v235, v102, v103
    v_cvt_pk_bf16_f32 v236, v104, v105
    v_cvt_pk_bf16_f32 v237, v106, v107
    v_cvt_pk_bf16_f32 v238, v108, v109
    v_cvt_pk_bf16_f32 v239, v110, v111
    s_nop 1
    v_permlane16_swap_b32 v208, v212
    v_permlane16_swap_b32 v209, v213
    v_permlane16_swap_b32 v210, v214
    v_permlane16_swap_b32_e64 v211, v215
    buffer_store_dwordx4 v[208:211], v2, s[16:19], s54 offen offset:0 sc1
    buffer_store_dwordx4 v[212:215], v2, s[16:19], s54 offen offset:1024 sc1
    v_permlane16_swap_b32 v232, v236
    v_permlane16_swap_b32 v233, v237
    v_permlane16_swap_b32 v234, v238
    v_permlane16_swap_b32 v235, v239
    buffer_store_dwordx4 v[232:235], v2, s[16:19], s54 offen offset:2048 sc1
    buffer_store_dwordx4 v[236:239], v2, s[16:19], s54 offen offset:3072 sc1
    s_lshl_b32 s7, s45, 12
    v_add_u32 v7, s7, v2
    v_mov_b32_e64 v5, v7
    v_add_u32 v6, 32768, v7
    s_mov_b32 s36, 32768
    v_mov_b32 v112, 0
    v_mov_b32 v113, 0
    v_mov_b32 v114, 0
    v_mov_b32 v115, 0
    v_mov_b32 v116, 0
    v_mov_b32 v117, 0
    v_mov_b32 v118, 0
    v_mov_b32 v119, 0
    v_mov_b32 v120, 0
    v_mov_b32 v121, 0
    v_mov_b32 v122, 0
    v_mov_b32 v123, 0
    v_mov_b32 v124, 0
    v_mov_b32 v125, 0
    v_mov_b32 v126, 0
    v_mov_b32 v127, 0
    v_mov_b32 v144, 0
    v_mov_b32 v145, 0
    v_mov_b32 v146, 0
    v_mov_b32 v147, 0
    v_mov_b32 v128, 0
    v_mov_b32 v129, 0
    v_mov_b32 v130, 0
    v_mov_b32 v131, 0
    v_mov_b32 v132, 0
    v_mov_b32 v133, 0
    v_mov_b32 v134, 0
    v_mov_b32 v135, 0
    v_mov_b32 v136, 0
    v_mov_b32 v137, 0
    v_mov_b32 v138, 0
    v_mov_b32 v139, 0
    v_mov_b32 v140, 0
    v_mov_b32 v141, 0
    v_mov_b32 v142, 0
    v_mov_b32 v143, 0
    v_mov_b32 v148, 0
    v_mov_b32 v149, 0
    v_mov_b32 v150, 0
    v_mov_b32 v151, 0
    v_mov_b32 v104, 0
    v_mov_b32 v105, 0
    v_mov_b32 v106, 0
    v_mov_b32 v107, 0
    v_mov_b32 v108, 0
    v_mov_b32 v109, 0
    v_mov_b32 v110, 0
    v_mov_b32 v111, 0
    v_mov_b32 v72, 0
    v_mov_b32 v73, 0
    v_mov_b32 v74, 0
    v_mov_b32 v75, 0
    v_mov_b32 v76, 0
    v_mov_b32 v77, 0
    v_mov_b32 v78, 0
    v_mov_b32 v79, 0
    v_and_b32 v14, 8, v1
    v_cmp_eq_u32 vcc, 0, v14
    s_nop 1
    v_cndmask_b32 v204, 0, v44, vcc
    v_cndmask_b32 v205, 0, v45, vcc
    v_cndmask_b32 v206, 0, v46, vcc
    v_cndmask_b32 v207, 0, v47, vcc
    s_bitcmp1_b32 s2, 2
    s_cselect_b32 s8, s96, s30
    s_cselect_b32 s9, s97, s31
    s_mov_b32 s10, 0x200000
    s_mov_b32 s12, s98
    s_mov_b32 s13, s99
    s_mov_b32 s14, 0x800000
    s_add_u32 s37, s43, 12582912
    s_lshl_b32 s38, s32, 11
    s_add_u32 s38, s38, 19922944
    s_lshl_b32 s39, s32, 16
    s_lshl_b32 s7, s6, 10
    s_add_u32 s39, s39, s7
    s_add_u32 s39, s39, 16777216
    s_lshl_b32 s42, s32, 13
    s_lshl_b32 s7, s6, 5
    s_add_u32 s42, s42, s7
    s_add_u32 s42, s42, 18874368
    s_lshl_b32 s62, s34, 5
    s_add_u32 s62, s62, s32
    s_lshl_b32 s62, s62, 11
    s_add_u32 s62, s62, 20971520
    s_add_u32 s63, s62, 4194304
    s_add_u32 s64, s35, 2048
    v_lshrrev_b32 v15, 5, v1
    v_and_b32 v16, 31, v1
    v_lshlrev_b32_e64 v16, 8, v16
    v_lshl_add_u32 v8, v15, 4, v16
    s_and_b32 s68, s2, 3
    s_lshl_b32 s68, s68, 2
    s_bfe_u32 s7, s2, 0x20003
    s_add_u32 s68, s68, s7
    s_lshr_b32 s69, s2, 5
    v_lshrrev_b32 v14, 4, v1
    v_and_b32 v15, 15, v1
    v_lshlrev_b32 v16, 1, v14
    v_xor_b32 v16, v16, v15
    v_lshlrev_b32_e64 v16, 4, v16
    v_lshl_add_u32 v3, v14, 11, v16
    v_xor_b32 v4, 128, v3
    v_add_u32 v4, 7168, v4
    s_lshl_b32 s65, s6, 14
    s_lshl_b32 s7, s69, 8
    s_add_u32 s65, s65, s7
    s_add_u32 s66, s68, s69
    s_and_b32 s66, s66, 1
    s_lshl_b32 s66, s66, 3
    s_lshl_b32 s67, s6, 11
    s_cmp_lg_u32 s6, 0
    s_cbranch_scc1 OKV_62
    s_mov_b32 s27, 0x40000
    v_mov_b32 v19, 0
PV_63:
    s_waitcnt vmcnt(0)
    v_cmp_ne_u32 vcc, 1, v13
    s_nop 4
    s_cbranch_vccz OKV_62
    buffer_load_dword v13, v19, s[20:23], 0 offen sc1
    s_sub_u32 s27, s27, 1
    s_cbranch_scc0 PV_63
OKV_62:
    s_waitcnt vmcnt(0)
    s_barrier
    s_cmp_lg_u32 s6, 0
    s_cbranch_scc1 NF_64
    v_mov_b32_e64 v14, 0
    v_mov_b32 v15, 1
    s_mov_b64 exec, 1
    buffer_store_dword v15, v14, s[16:19], s60 offen sc1
    s_mov_b64 exec, -1
NF_64:
    s_branch ATT_60
TAILA_49:
    s_waitcnt vmcnt(8) lgkmcnt(0)
    s_barrier
    v_mfma_f32_16x16x32_bf16 v[48:51], v[160:163], v[144:147], v[48:51]
    ds_read_b128 v[184:187], v9 offset:0
    v_mfma_f32_16x16x32_bf16 v[52:55], v[164:167], v[144:147], v[52:55]
    ds_read_b64_tr_b16 v[200:201], v10 offset:0
    v_mfma_f32_16x16x32_bf16 v[64:67], v[168:171], v[144:147], v[64:67]
    ds_read_b64_tr_b16 v[202:203], v10 offset:512
    v_mfma_f32_16x16x32_bf16 v[68:71], v[172:175], v[144:147], v[68:71]
    ds_read_b128 v[188:191], v9 offset:2048
    v_mfma_f32_16x16x32_bf16 v[80:83], v[144:147], v[176:179], v[80:83]
    ds_read_b64_tr_b16 v[204:205], v11 offset:0
    v_mfma_f32_16x16x32_bf16 v[84:87], v[144:147], v[180:183], v[84:87]
    ds_read_b64_tr_b16 v[206:207], v11 offset:512
    v_mfma_f32_16x16x32_bf16 v[92:95], v[148:151], v[180:183], v[92:95]
    ds_read_b128 v[192:195], v9 offset:4096
    v_mfma_f32_16x16x32_bf16 v[88:91], v[148:151], v[176:179], v[88:91]
    ds_read_b64_tr_b16 v[208:209], v10 offset:4096
    v_mfma_f32_16x16x32_bf16 v[76:79], v[172:175], v[148:151], v[76:79]
    ds_read_b64_tr_b16 v[210:211], v10 offset:4608
    v_mfma_f32_16x16x32_bf16 v[72:75], v[168:171], v[148:151], v[72:75]
    ds_read_b128 v[196:199], v9 offset:6144
    v_mfma_f32_16x16x32_bf16 v[60:63], v[164:167], v[148:151], v[60:63]
    ds_read_b64_tr_b16 v[212:213], v11 offset:4096
    v_mfma_f32_16x16x32_bf16 v[56:59], v[160:163], v[148:151], v[56:59]
    ds_read_b64_tr_b16 v[214:215], v11 offset:4608
    v_mfma_f32_16x16x32_bf16 v[96:99], v[160:163], v[152:155], v[96:99]
    ds_read_b64_tr_b16 v[216:217], v10 offset:8192
    v_mfma_f32_16x16x32_bf16 v[100:103], v[164:167], v[152:155], v[100:103]
    ds_read_b64_tr_b16 v[218:219], v10 offset:8704
    v_mfma_f32_16x16x32_bf16 v[112:115], v[168:171], v[152:155], v[112:115]
    ds_read_b64_tr_b16 v[220:221], v11 offset:8192
    v_mfma_f32_16x16x32_bf16 v[116:119], v[172:175], v[152:155], v[116:119]
    ds_read_b64_tr_b16 v[222:223], v11 offset:8704
    v_mfma_f32_16x16x32_bf16 v[128:131], v[152:155], v[176:179], v[128:131]
    s_mov_b32 s36, s37
    s_mov_b32 s38, s39
    s_add_u32 s37, s36, 12288
    s_cmp_eq_u32 s37, 159744
    s_cselect_b32 s37, 98304, s37
    s_add_u32 s39, s38, 32768
    s_cmp_eq_u32 s39, 98304
    s_cselect_b32 s39, 0, s39
    v_add_u32 v9, s39, v5
    v_add_u32 v10, s37, v7
    v_add_u32 v11, s37, v8
    v_mfma_f32_16x16x32_bf16 v[132:135], v[152:155], v[180:183], v[132:135]
    v_mfma_f32_16x16x32_bf16 v[140:143], v[156:159], v[180:183], v[140:143]
    v_mfma_f32_16x16x32_bf16 v[136:139], v[156:159], v[176:179], v[136:139]
    v_mfma_f32_16x16x32_bf16 v[124:127], v[172:175], v[156:159], v[124:127]
    v_mfma_f32_16x16x32_bf16 v[120:123], v[168:171], v[156:159], v[120:123]
    v_mfma_f32_16x16x32_bf16 v[108:111], v[164:167], v[156:159], v[108:111]
    v_mfma_f32_16x16x32_bf16 v[104:107], v[160:163], v[156:159], v[104:107]
    s_waitcnt vmcnt(2) lgkmcnt(0)
    s_barrier
    v_mfma_f32_16x16x32_bf16 v[48:51], v[200:203], v[184:187], v[48:51]
    ds_read_b128 v[144:147], v9 offset:0
    v_mfma_f32_16x16x32_bf16 v[52:55], v[204:207], v[184:187], v[52:55]
    ds_read_b64_tr_b16 v[160:161], v10 offset:0
    v_mfma_f32_16x16x32_bf16 v[64:67], v[208:211], v[184:187], v[64:67]
    ds_read_b64_tr_b16 v[162:163], v10 offset:512
    v_mfma_f32_16x16x32_bf16 v[68:71], v[212:215], v[184:187], v[68:71]
    ds_read_b128 v[148:151], v9 offset:2048
    v_mfma_f32_16x16x32_bf16 v[80:83], v[184:187], v[216:219], v[80:83]
    ds_read_b64_tr_b16 v[164:165], v11 offset:0
    v_mfma_f32_16x16x32_bf16 v[84:87], v[184:187], v[220:223], v[84:87]
    ds_read_b64_tr_b16 v[166:167], v11 offset:512
    v_mfma_f32_16x16x32_bf16 v[92:95], v[188:191], v[220:223], v[92:95]
    ds_read_b128 v[152:155], v9 offset:4096
    v_mfma_f32_16x16x32_bf16 v[88:91], v[188:191], v[216:219], v[88:91]
    ds_read_b64_tr_b16 v[168:169], v10 offset:4096
    v_mfma_f32_16x16x32_bf16 v[76:79], v[212:215], v[188:191], v[76:79]
    ds_read_b64_tr_b16 v[170:171], v10 offset:4608
    v_mfma_f32_16x16x32_bf16 v[72:75], v[208:211], v[188:191], v[72:75]
    ds_read_b128 v[156:159], v9 offset:6144
    v_mfma_f32_16x16x32_bf16 v[60:63], v[204:207], v[188:191], v[60:63]
    ds_read_b64_tr_b16 v[172:173], v11 offset:4096
    v_mfma_f32_16x16x32_bf16 v[56:59], v[200:203], v[188:191], v[56:59]
    ds_read_b64_tr_b16 v[174:175], v11 offset:4608
    v_mfma_f32_16x16x32_bf16 v[96:99], v[200:203], v[192:195], v[96:99]
    ds_read_b64_tr_b16 v[176:177], v10 offset:8192
    v_mfma_f32_16x16x32_bf16 v[100:103], v[204:207], v[192:195], v[100:103]
    ds_read_b64_tr_b16 v[178:179], v10 offset:8704
    v_mfma_f32_16x16x32_bf16 v[112:115], v[208:211], v[192:195], v[112:115]
    ds_read_b64_tr_b16 v[180:181], v11 offset:8192
    v_mfma_f32_16x16x32_bf16 v[116:119], v[212:215], v[192:195], v[116:119]
    ds_read_b64_tr_b16 v[182:183], v11 offset:8704
    v_mfma_f32_16x16x32_bf16 v[128:131], v[192:195], v[216:219], v[128:131]
    s_mov_b32 s36, s37
    s_add_u32 s37, s36, 12288
    s_cmp_eq_u32 s37, 159744
    s_cselect_b32 s37, 98304, s37
    v_add_u32 v9, s39, v6
    v_add_u32 v10, s37, v7
    v_add_u32 v11, s37, v8
    v_mfma_f32_16x16x32_bf16 v[132:135], v[192:195], v[220:223], v[132:135]
    v_mfma_f32_16x16x32_bf16 v[140:143], v[196:199], v[220:223], v[140:143]
    v_mfma_f32_16x16x32_bf16 v[136:139], v[196:199], v[216:219], v[136:139]
    v_mfma_f32_16x16x32_bf16 v[124:127], v[212:215], v[196:199], v[124:127]
    v_mfma_f32_16x16x32_bf16 v[120:123], v[208:211], v[196:199], v[120:123]
    v_mfma_f32_16x16x32_bf16 v[108:111], v[204:207], v[196:199], v[108:111]
    v_mfma_f32_16x16x32_bf16 v[104:107], v[200:203], v[196:199], v[104:107]
    s_waitcnt vmcnt(1) lgkmcnt(0)
    s_barrier
    v_mfma_f32_16x16x32_bf16 v[48:51], v[160:163], v[144:147], v[48:51]
    ds_read_b128 v[184:187], v9 offset:0
    v_mfma_f32_16x16x32_bf16 v[52:55], v[164:167], v[144:147], v[52:55]
    ds_read_b64_tr_b16 v[200:201], v10 offset:0
    v_mfma_f32_16x16x32_bf16 v[64:67], v[168:171], v[144:147], v[64:67]
    ds_read_b64_tr_b16 v[202:203], v10 offset:512
    v_mfma_f32_16x16x32_bf16 v[68:71], v[172:175], v[144:147], v[68:71]
    ds_read_b128 v[188:191], v9 offset:2048
    v_mfma_f32_16x16x32_bf16 v[80:83], v[144:147], v[176:179], v[80:83]
    ds_read_b64_tr_b16 v[204:205], v11 offset:0
    v_mfma_f32_16x16x32_bf16 v[84:87], v[144:147], v[180:183], v[84:87]
    ds_read_b64_tr_b16 v[206:207], v11 offset:512
    v_mfma_f32_16x16x32_bf16 v[92:95], v[148:151], v[180:183], v[92:95]
    ds_read_b128 v[192:195], v9 offset:4096
    v_mfma_f32_16x16x32_bf16 v[88:91], v[148:151], v[176:179], v[88:91]
    ds_read_b64_tr_b16 v[208:209], v10 offset:4096
    v_mfma_f32_16x16x32_bf16 v[76:79], v[172:175], v[148:151], v[76:79]
    ds_read_b64_tr_b16 v[210:211], v10 offset:4608
    v_mfma_f32_16x16x32_bf16 v[72:75], v[168:171], v[148:151], v[72:75]
    ds_read_b128 v[196:199], v9 offset:6144
    v_mfma_f32_16x16x32_bf16 v[60:63], v[164:167], v[148:151], v[60:63]
    ds_read_b64_tr_b16 v[212:213], v11 offset:4096
    v_mfma_f32_16x16x32_bf16 v[56:59], v[160:163], v[148:151], v[56:59]
    ds_read_b64_tr_b16 v[214:215], v11 offset:4608
    v_mfma_f32_16x16x32_bf16 v[96:99], v[160:163], v[152:155], v[96:99]
    ds_read_b64_tr_b16 v[216:217], v10 offset:8192
    v_mfma_f32_16x16x32_bf16 v[100:103], v[164:167], v[152:155], v[100:103]
    ds_read_b64_tr_b16 v[218:219], v10 offset:8704
    v_mfma_f32_16x16x32_bf16 v[112:115], v[168:171], v[152:155], v[112:115]
    ds_read_b64_tr_b16 v[220:221], v11 offset:8192
    v_mfma_f32_16x16x32_bf16 v[116:119], v[172:175], v[152:155], v[116:119]
    ds_read_b64_tr_b16 v[222:223], v11 offset:8704
    v_mfma_f32_16x16x32_bf16 v[128:131], v[152:155], v[176:179], v[128:131]
    s_cmp_lg_u32 s6, 0
    s_cbranch_scc1 NI_50
    buffer_load_dword v13, v224, s[20:23], 0 offen sc1
NI_50:
    v_mfma_f32_16x16x32_bf16 v[132:135], v[152:155], v[180:183], v[132:135]
    s_mov_b32 s36, s37
    s_mov_b32 s38, s39
    s_add_u32 s37, s36, 12288
    s_cmp_eq_u32 s37, 159744
    s_cselect_b32 s37, 98304, s37
    s_add_u32 s39, s38, 32768
    s_cmp_eq_u32 s39, 98304
    s_cselect_b32 s39, 0, s39
    s_nop 0
    v_mfma_f32_16x16x32_bf16 v[140:143], v[156:159], v[180:183], v[140:143]
    v_mfma_f32_16x16x32_bf16 v[136:139], v[156:159], v[176:179], v[136:139]
    v_mfma_f32_16x16x32_bf16 v[124:127], v[172:175], v[156:159], v[124:127]
    v_mfma_f32_16x16x32_bf16 v[120:123], v[168:171], v[156:159], v[120:123]
    v_mfma_f32_16x16x32_bf16 v[108:111], v[164:167], v[156:159], v[108:111]
    v_mfma_f32_16x16x32_bf16 v[104:107], v[160:163], v[156:159], v[104:107]
    s_waitcnt vmcnt(63) lgkmcnt(0)
    s_barrier
    v_mfma_f32_16x16x32_bf16 v[48:51], v[200:203], v[184:187], v[48:51]
    v_mfma_f32_16x16x32_bf16 v[52:55], v[204:207], v[184:187], v[52:55]
    v_mfma_f32_16x16x32_bf16 v[64:67], v[208:211], v[184:187], v[64:67]
    v_mfma_f32_16x16x32_bf16 v[68:71], v[212:215], v[184:187], v[68:71]
    v_mfma_f32_16x16x32_bf16 v[80:83], v[184:187], v[216:219], v[80:83]
    v_mfma_f32_16x16x32_bf16 v[84:87], v[184:187], v[220:223], v[84:87]
    v_mfma_f32_16x16x32_bf16 v[92:95], v[188:191], v[220:223], v[92:95]
    v_mfma_f32_16x16x32_bf16 v[88:91], v[188:191], v[216:219], v[88:91]
    v_mfma_f32_16x16x32_bf16 v[76:79], v[212:215], v[188:191], v[76:79]
    v_mfma_f32_16x16x32_bf16 v[72:75], v[208:211], v[188:191], v[72:75]
    v_mfma_f32_16x16x32_bf16 v[60:63], v[204:207], v[188:191], v[60:63]
    v_mfma_f32_16x16x32_bf16 v[56:59], v[200:203], v[188:191], v[56:59]
    v_mfma_f32_16x16x32_bf16 v[96:99], v[200:203], v[192:195], v[96:99]
    v_mfma_f32_16x16x32_bf16 v[100:103], v[204:207], v[192:195], v[100:103]
    v_mfma_f32_16x16x32_bf16 v[112:115], v[208:211], v[192:195], v[112:115]
    v_mfma_f32_16x16x32_bf16 v[116:119], v[212:215], v[192:195], v[116:119]
    v_mfma_f32_16x16x32_bf16 v[128:131], v[192:195], v[216:219], v[128:131]
    v_mfma_f32_16x16x32_bf16 v[132:135], v[192:195], v[220:223], v[132:135]
    v_mfma_f32_16x16x32_bf16 v[140:143], v[196:199], v[220:223], v[140:143]
    v_mfma_f32_16x16x32_bf16 v[136:139], v[196:199], v[216:219], v[136:139]
    v_mfma_f32_16x16x32_bf16 v[124:127], v[212:215], v[196:199], v[124:127]
    v_mfma_f32_16x16x32_bf16 v[120:123], v[208:211], v[196:199], v[120:123]
    v_mfma_f32_16x16x32_bf16 v[108:111], v[204:207], v[196:199], v[108:111]
    v_mfma_f32_16x16x32_bf16 v[104:107], v[200:203], v[196:199], v[104:107]
    v_lshlrev_b32_e64 v2, 4, v1
    s_lshl_b32 s43, s32, 6
    s_add_u32 s43, s43, s34
    s_lshl_b32 s43, s43, 11
    s_lshl_b32 s41, s32, 18
    s_add_u32 s41, s41, 4194304
    s_lshl_b32 s44, s6, 12
    s_add_u32 s40, s41, s44
    s_lshr_b32 s45, s6, 2
    s_add_u32 s46, s43, 0
    s_xor_b32 s47, s46, 2048
EPA_48:
    ds_read_b64_tr_b16 v[176:177], v27 offset:0
    ds_read_b64_tr_b16 v[178:179], v27 offset:1024
    ds_read_b64_tr_b16 v[180:181], v27 offset:256
    ds_read_b64_tr_b16 v[182:183], v27 offset:1280
    v_cvt_pk_bf16_f32 v144, v64, v65
    v_cvt_pk_bf16_f32 v145, v66, v67
    v_cvt_pk_bf16_f32 v146, v68, v69
    v_cvt_pk_bf16_f32 v147, v70, v71
    v_cvt_pk_bf16_f32 v148, v72, v73
    v_cvt_pk_bf16_f32 v149, v74, v75
    v_cvt_pk_bf16_f32 v150, v76, v77
    v_cvt_pk_bf16_f32 v151, v78, v79
    v_cvt_pk_bf16_f32 v152, v112, v113
    v_cvt_pk_bf16_f32 v153, v114, v115
    v_cvt_pk_bf16_f32 v154, v116, v117
    v_cvt_pk_bf16_f32 v155, v118, v119
    v_cvt_pk_bf16_f32 v156, v120, v121
    v_cvt_pk_bf16_f32 v157, v122, v123
    v_cvt_pk_bf16_f32 v158, v124, v125
    v_cvt_pk_bf16_f32 v159, v126, v127
    v_cvt_pk_bf16_f32 v208, v48, v49
    v_cvt_pk_bf16_f32 v209, v50, v51
    v_cvt_pk_bf16_f32 v210, v52, v53
    v_cvt_pk_bf16_f32 v211, v54, v55
    v_cvt_pk_bf16_f32 v212, v56, v57
    v_cvt_pk_bf16_f32 v213, v58, v59
    v_cvt_pk_bf16_f32 v214, v60, v61
    v_cvt_pk_bf16_f32 v215, v62, v63
    v_permlane16_swap_b32 v144, v148
    v_permlane16_swap_b32 v145, v149
    v_permlane16_swap_b32 v146, v150
    v_permlane16_swap_b32 v147, v151
    v_permlane16_swap_b32 v152, v156
    v_permlane16_swap_b32 v153, v157
    v_permlane16_swap_b32 v154, v158
    v_permlane16_swap_b32 v155, v159
    s_waitcnt lgkmcnt(0)
    s_nop 0
    v_mfma_f32_32x32x16_bf16 v[64:79], v[176:179], v[144:147], 0
    v_mfma_f32_32x32x16_bf16 v[64:79], v[180:183], v[148:151], v[64:79]
    v_mfma_f32_32x32x16_bf16 v[112:127], v[176:179], v[152:155], 0
    v_mfma_f32_32x32x16_bf16 v[112:127], v[180:183], v[156:159], v[112:127]
    v_cvt_pk_bf16_f32 v216, v96, v97
    v_cvt_pk_bf16_f32 v217, v98, v99
    v_cvt_pk_bf16_f32 v218, v100, v101
    v_cvt_pk_bf16_f32 v219, v102, v103
    v_cvt_pk_bf16_f32 v220, v104, v105
    v_cvt_pk_bf16_f32 v221, v106, v107
    v_cvt_pk_bf16_f32 v222, v108, v109
    v_cvt_pk_bf16_f32 v223, v110, v111
    v_cvt_pk_bf16_f32 v160, v80, v81
    v_cvt_pk_bf16_f32 v161, v82, v83
    v_cvt_pk_bf16_f32 v162, v84, v85
    v_cvt_pk_bf16_f32 v163, v86, v87
    v_cvt_pk_bf16_f32 v164, v88, v89
    v_cvt_pk_bf16_f32 v165, v90, v91
    v_cvt_pk_bf16_f32 v166, v92, v93
    v_cvt_pk_bf16_f32 v167, v94, v95
    v_cvt_pk_bf16_f32 v168, v128, v129
    v_cvt_pk_bf16_f32 v169, v130, v131
    v_cvt_pk_bf16_f32 v170, v132, v133
    v_cvt_pk_bf16_f32 v171, v134, v135
    v_cvt_pk_bf16_f32 v172, v136, v137
    v_cvt_pk_bf16_f32 v173, v138, v139
    v_cvt_pk_bf16_f32 v174, v140, v141
    v_cvt_pk_bf16_f32 v175, v142, v143
    v_mov_b32 v184, 0
    v_mov_b32 v188, 0
    v_permlane16_swap_b32 v208, v212
    v_permlane16_swap_b32 v209, v213
    v_permlane16_swap_b32 v210, v214
    v_permlane16_swap_b32 v211, v215
    v_permlane16_swap_b32 v216, v220
    v_permlane16_swap_b32 v217, v221
    v_permlane16_swap_b32 v218, v222
    v_permlane16_swap_b32 v219, v223
    v_permlane16_swap_b32 v160, v162
    v_permlane16_swap_b32 v161, v163
    v_permlane16_swap_b32 v164, v166
    v_permlane16_swap_b32 v165, v167
    v_permlane16_swap_b32 v168, v170
    v_permlane16_swap_b32 v169, v171
    v_permlane16_swap_b32 v172, v174
    v_permlane16_swap_b32 v173, v175
    v_mov_b32 v192, 0
    v_mov_b32 v196, 0
    v_pk_mul_f32 v[64:65], v[64:65], s[24:25]
    v_pk_mul_f32 v[66:67], v[66:67], s[24:25]
    v_pk_mul_f32 v[68:69], v[68:69], s[24:25]
    v_pk_mul_f32 v[70:71], v[70:71], s[24:25]
    v_pk_mul_f32 v[72:73], v[72:73], s[24:25]
    v_pk_mul_f32 v[74:75], v[74:75], s[24:25]
    v_pk_mul_f32 v[76:77], v[76:77], s[24:25]
    v_pk_mul_f32 v[78:79], v[78:79], s[24:25]
    v_exp_f32 v48, -v64
    v_exp_f32_e64 v64, v64
    v_exp_f32 v49, -v65
    v_exp_f32_e64 v65, v65
    v_exp_f32 v50, -v66
    v_exp_f32_e64 v66, v66
    v_exp_f32 v51, -v67
    v_exp_f32_e64 v67, v67
    v_exp_f32 v52, -v68
    v_exp_f32_e64 v68, v68
    v_exp_f32 v53, -v69
    v_exp_f32_e64 v69, v69
    v_exp_f32 v54, -v70
    v_exp_f32_e64 v70, v70
    v_exp_f32 v55, -v71
    v_exp_f32_e64 v71, v71
    v_exp_f32 v56, -v72
    v_exp_f32_e64 v72, v72
    v_exp_f32 v57, -v73
    v_exp_f32_e64 v73, v73
    v_smfmac_f32_16x16x64_bf16 v[196:199], v[44:47], v[48:55], v26
    v_smfmac_f32_16x16x64_bf16 v[192:195], v[44:47], v[64:71], v26
    v_exp_f32 v58, -v74
    v_exp_f32_e64 v74, v74
    v_exp_f32 v59, -v75
    v_exp_f32_e64 v75, v75
    v_exp_f32 v60, -v76
    v_exp_f32_e64 v76, v76
    v_exp_f32 v61, -v77
    v_exp_f32_e64 v77, v77
    v_exp_f32 v62, -v78
    v_exp_f32_e64 v78, v78
    v_exp_f32 v63, -v79
    v_exp_f32 v79, v79
    s_nop 1
    v_smfmac_f32_16x16x64_bf16 v[196:199], v[44:47], v[56:63], v26
    v_smfmac_f32_16x16x64_bf16 v[192:195], v[44:47], v[72:79], v26
    v_mov_b32 v200, 0
    v_mov_b32 v204, 0
    v_pk_mul_f32 v[112:113], v[112:113], s[24:25]
    v_pk_mul_f32 v[114:115], v[114:115], s[24:25]
    v_pk_mul_f32 v[116:117], v[116:117], s[24:25]
    v_pk_mul_f32 v[118:119], v[118:119], s[24:25]
    v_pk_mul_f32 v[120:121], v[120:121], s[24:25]
    v_pk_mul_f32 v[122:123], v[122:123], s[24:25]
    v_pk_mul_f32 v[124:125], v[124:125], s[24:25]
    v_pk_mul_f32 v[126:127], v[126:127], s[24:25]
    v_exp_f32 v96, -v112
    v_exp_f32_e64 v112, v112
    v_exp_f32 v97, -v113
    v_exp_f32_e64 v113, v113
    v_exp_f32 v98, -v114
    v_exp_f32_e64 v114, v114
    v_exp_f32 v99, -v115
    v_exp_f32_e64 v115, v115
    v_exp_f32 v100, -v116
    v_exp_f32_e64 v116, v116
    v_exp_f32 v101, -v117
    v_exp_f32_e64 v117, v117
    v_exp_f32 v102, -v118
    v_exp_f32_e64 v118, v118
    v_exp_f32 v103, -v119
    v_exp_f32_e64 v119, v119
    v_exp_f32 v104, -v120
    v_exp_f32_e64 v120, v120
    v_exp_f32 v105, -v121
    v_exp_f32_e64 v121, v121
    v_smfmac_f32_16x16x64_bf16 v[204:207], v[44:47], v[96:103], v26
    v_smfmac_f32_16x16x64_bf16 v[200:203], v[44:47], v[112:119], v26
    v_exp_f32 v106, -v122
    v_exp_f32_e64 v122, v122
    v_exp_f32 v107, -v123
    v_exp_f32_e64 v123, v123
    v_exp_f32 v108, -v124
    v_exp_f32_e64 v124, v124
    v_exp_f32 v109, -v125
    v_exp_f32_e64 v125, v125
    v_exp_f32 v110, -v126
    v_exp_f32_e64 v126, v126
    v_exp_f32 v111, -v127
    v_exp_f32 v127, v127
    s_nop 1
    v_smfmac_f32_16x16x64_bf16 v[204:207], v[44:47], v[104:111], v26
    v_smfmac_f32_16x16x64_bf16 v[200:203], v[44:47], v[120:127], v26
    v_cmp_nge_f32 vcc, s26, v192
    v_cmp_nge_f32 s[28:29], s26, v196
    v_rcp_f32 v192, v192
    v_rcp_f32_e64 v196, v196
    s_or_b64 vcc, vcc, s[28:29]
    s_cbranch_scc1 FSLOW_65
    v_pk_mul_f32 v[64:65], v[64:65], v[192:193] op_sel_hi:[1,0]
    v_pk_mul_f32 v[48:49], v[48:49], v[196:197] op_sel_hi:[1,0]
    v_pk_mul_f32 v[66:67], v[66:67], v[192:193] op_sel_hi:[1,0]
    v_pk_mul_f32 v[50:51], v[50:51], v[196:197] op_sel_hi:[1,0]
    v_pk_mul_f32 v[68:69], v[68:69], v[192:193] op_sel_hi:[1,0]
    v_pk_mul_f32 v[52:53], v[52:53], v[196:197] op_sel_hi:[1,0]
    v_pk_mul_f32 v[70:71], v[70:71], v[192:193] op_sel_hi:[1,0]
    v_pk_mul_f32 v[54:55], v[54:55], v[196:197] op_sel_hi:[1,0]
    v_pk_mul_f32 v[72:73], v[72:73], v[192:193] op_sel_hi:[1,0]
    v_pk_mul_f32 v[56:57], v[56:57], v[196:197] op_sel_hi:[1,0]
    v_pk_mul_f32 v[74:75], v[74:75], v[192:193] op_sel_hi:[1,0]
    v_pk_mul_f32 v[58:59], v[58:59], v[196:197] op_sel_hi:[1,0]
    v_pk_mul_f32 v[76:77], v[76:77], v[192:193] op_sel_hi:[1,0]
    v_pk_mul_f32 v[60:61], v[60:61], v[196:197] op_sel_hi:[1,0]
    v_pk_mul_f32 v[78:79], v[78:79], v[192:193] op_sel_hi:[1,0]
    v_pk_mul_f32 v[62:63], v[62:63], v[196:197] op_sel_hi:[1,0]
    v_cvt_pk_bf16_f32 v144, v64, v65
    v_cvt_pk_bf16_f32 v80, v48, v49
    v_cvt_pk_bf16_f32 v145, v66, v67
    v_cvt_pk_bf16_f32 v81, v50, v51
    v_cvt_pk_bf16_f32 v146, v68, v69
    v_cvt_pk_bf16_f32 v82, v52, v53
    v_cvt_pk_bf16_f32 v147, v70, v71
    v_cvt_pk_bf16_f32 v83, v54, v55
    v_cvt_pk_bf16_f32 v148, v72, v73
    v_cvt_pk_bf16_f32 v84, v56, v57
    v_cvt_pk_bf16_f32 v149, v74, v75
    v_cvt_pk_bf16_f32 v85, v58, v59
    v_cvt_pk_bf16_f32 v150, v76, v77
    v_cvt_pk_bf16_f32 v86, v60, v61
    v_cvt_pk_bf16_f32 v151, v78, v79
    v_cvt_pk_bf16_f32 v87, v62, v63
FBACK_66:
    s_nop 1
    s_nop 0
    v_mfma_f32_32x32x16_bf16 v[64:79], v[144:147], v[36:39], 0
    v_mfma_f32_32x32x16_bf16 v[48:63], v[80:83], v[36:39], 0
    v_mfma_f32_32x32x16_bf16 v[64:79], v[148:151], v[40:43], v[64:79]
    v_mfma_f32_32x32x16_bf16 v[48:63], v[84:87], v[40:43], v[48:63]
    v_cmp_nge_f32 vcc, s26, v200
    v_cmp_nge_f32 s[28:29], s26, v204
    v_rcp_f32 v200, v200
    v_rcp_f32_e64 v204, v204
    s_or_b64 vcc, vcc, s[28:29]
    s_cbranch_scc1 FSLOW_67
    v_pk_mul_f32 v[112:113], v[112:113], v[200:201] op_sel_hi:[1,0]
    v_pk_mul_f32 v[96:97], v[96:97], v[204:205] op_sel_hi:[1,0]
    v_pk_mul_f32 v[114:115], v[114:115], v[200:201] op_sel_hi:[1,0]
    v_pk_mul_f32 v[98:99], v[98:99], v[204:205] op_sel_hi:[1,0]
    v_pk_mul_f32 v[116:117], v[116:117], v[200:201] op_sel_hi:[1,0]
    v_pk_mul_f32 v[100:101], v[100:101], v[204:205] op_sel_hi:[1,0]
    v_pk_mul_f32 v[118:119], v[118:119], v[200:201] op_sel_hi:[1,0]
    v_pk_mul_f32 v[102:103], v[102:103], v[204:205] op_sel_hi:[1,0]
    v_pk_mul_f32 v[120:121], v[120:121], v[200:201] op_sel_hi:[1,0]
    v_pk_mul_f32 v[104:105], v[104:105], v[204:205] op_sel_hi:[1,0]
    v_pk_mul_f32 v[122:123], v[122:123], v[200:201] op_sel_hi:[1,0]
    v_pk_mul_f32 v[106:107], v[106:107], v[204:205] op_sel_hi:[1,0]
    v_pk_mul_f32 v[124:125], v[124:125], v[200:201] op_sel_hi:[1,0]
    v_pk_mul_f32 v[108:109], v[108:109], v[204:205] op_sel_hi:[1,0]
    v_pk_mul_f32 v[126:127], v[126:127], v[200:201] op_sel_hi:[1,0]
    v_pk_mul_f32 v[110:111], v[110:111], v[204:205] op_sel_hi:[1,0]
    v_cvt_pk_bf16_f32 v152, v112, v113
    v_cvt_pk_bf16_f32 v128, v96, v97
    v_cvt_pk_bf16_f32 v153, v114, v115
    v_cvt_pk_bf16_f32 v129, v98, v99
    v_cvt_pk_bf16_f32 v154, v116, v117
    v_cvt_pk_bf16_f32 v130, v100, v101
    v_cvt_pk_bf16_f32 v155, v118, v119
    v_cvt_pk_bf16_f32 v131, v102, v103
    v_cvt_pk_bf16_f32 v156, v120, v121
    v_cvt_pk_bf16_f32 v132, v104, v105
    v_cvt_pk_bf16_f32 v157, v122, v123
    v_cvt_pk_bf16_f32 v133, v106, v107
    v_cvt_pk_bf16_f32 v158, v124, v125
    v_cvt_pk_bf16_f32 v134, v108, v109
    v_cvt_pk_bf16_f32 v159, v126, v127
    v_cvt_pk_bf16_f32 v135, v110, v111
FBACK_68:
    s_nop 1
    s_nop 0
    v_mfma_f32_32x32x16_bf16 v[112:127], v[152:155], v[36:39], 0
    v_mfma_f32_32x32x16_bf16 v[96:111], v[128:131], v[36:39], 0
    v_mfma_f32_32x32x16_bf16 v[112:127], v[156:159], v[40:43], v[112:127]
    v_mfma_f32_32x32x16_bf16 v[96:111], v[132:135], v[40:43], v[96:111]
    v_smfmac_f32_32x32x32_bf16 v[224:239], v[160:163], v[64:71], v26
    v_smfmac_f32_32x32x32_bf16 v[240:255], v[160:163], v[48:55], v26
    v_smfmac_f32_32x32x32_bf16 v[224:239], v[164:167], v[72:79], v26
    v_smfmac_f32_32x32x32_bf16 v[240:255], v[164:167], v[56:63], v26
    v_smfmac_f32_16x16x64_bf16 v[184:187], v[44:47], v[64:71], v26
    v_smfmac_f32_16x16x64_bf16 v[188:191], v[44:47], v[48:55], v26
    v_smfmac_f32_16x16x64_bf16 v[184:187], v[44:47], v[72:79], v26
    v_smfmac_f32_16x16x64_bf16 v[188:191], v[44:47], v[56:63], v26
    s_nop 3
    s_nop 0
    v_smfmac_f32_32x32x32_bf16 v[224:239], v[168:171], v[112:119], v26
    v_smfmac_f32_32x32x32_bf16 v[240:255], v[168:171], v[96:103], v26
    v_smfmac_f32_32x32x32_bf16 v[224:239], v[172:175], v[120:127], v26
    v_smfmac_f32_32x32x32_bf16 v[240:255], v[172:175], v[104:111], v26
    v_smfmac_f32_16x16x64_bf16 v[184:187], v[44:47], v[112:119], v26
    v_smfmac_f32_16x16x64_bf16 v[188:191], v[44:47], v[96:103], v26
    v_smfmac_f32_16x16x64_bf16 v[184:187], v[44:47], v[120:127], v26
    v_smfmac_f32_16x16x64_bf16 v[188:191], v[44:47], v[104:111], v26
    s_lshl_b32 s7, s6, 13
    s_add_u32 s7, s7, 65536
    v_add_u32 v14, s7, v2
    s_lshr_b32 s7, s6, 2
    s_lshl_b32 s49, s7, 15
    s_and_b32 s50, s6, 3
    s_lshl_b32 s61, s50, 11
    s_add_u32 s49, s49, s61
    s_add_u32 s49, s49, 65536
    v_add_u32 v17, s49, v2
    s_lshl_b32 s49, s51, 3
    s_add_u32 s49, s49, s4
    s_lshl_b32 s56, s49, 13
    s_add_u32 s56, s56, s61
    s_add_u32 s56, s56, 16777216
    s_lshl_b32 s57, s49, 10
    s_lshl_b32 s7, s50, 8
    s_add_u32 s57, s57, s7
    s_add_u32 s57, s57, 18874368
    s_lshl_b32 s54, s53, 11
    s_add_u32 s54, s54, 12582912
    ds_write_b128 v14, v[224:227] offset:0
    ds_write_b128 v14, v[228:231] offset:1024
    ds_write_b128 v14, v[232:235] offset:2048
    ds_write_b128 v14, v[236:239] offset:3072
    ds_write_b128 v14, v[240:243] offset:4096
    ds_write_b128 v14, v[244:247] offset:5120
    ds_write_b128 v14, v[248:251] offset:6144
    ds_write_b128 v14, v[252:255] offset:7168
    v_cmp_gt_u32 vcc, 32, v1
    v_lshlrev_b32 v18, 2, v1
    s_nop 0
    v_cndmask_b32 v184, v188, v184, vcc
    s_cmp_lg_u32 s6, 0
    s_cbranch_scc1 OKV_69
    s_mov_b32 s27, 0x40000
    v_mov_b32_e64 v19, 0
PV_70:
    s_waitcnt vmcnt(0)
    v_cmp_ne_u32 vcc, 1, v13
    s_nop 4
    s_cbranch_vccz OKV_69
    buffer_load_dword v13, v19, s[20:23], 0 offen sc1
    s_sub_u32 s27, s27, 1
    s_cbranch_scc0 PV_70
OKV_69:
    s_cmp_lg_u32 s6, 0
    s_cbranch_scc1 GO_71
    v_and_b32 v15, 7, v1
    v_lshlrev_b32 v15, 2, v15
    s_mov_b32 s27, 0x40000
PL_72:
    buffer_load_dword v16, v15, s[16:19], s35 offen sc1
    s_sub_u32 s27, s27, 1
    s_cbranch_scc1 GO_71
    s_waitcnt vmcnt(0)
    v_cmp_ne_u32 vcc, 1, v16
    s_nop 4
    s_cbranch_vccz GO_71
    s_sleep 1
    s_branch PL_72
GO_71:
    s_waitcnt lgkmcnt(0)
    s_barrier
    s_add_u32 m0, s44, 0
    s_nop 0
    buffer_load_dwordx4 v2, s[16:19], s40 offen offset:0 sc1 lds
    buffer_load_dwordx4 v2, s[16:19], s40 offen offset:1024 sc1 lds
    buffer_load_dwordx4 v2, s[16:19], s40 offen offset:2048 sc1 lds
    buffer_load_dwordx4 v2, s[16:19], s40 offen offset:3072 sc1 lds
    s_add_u32 s40, s40, 32768
    s_barrier
    s_nop 0
    buffer_load_dwordx4 v[28:31], v2, s[16:19], s46 offen offset:0 sc1
    buffer_load_dwordx4 v[32:35], v2, s[16:19], s46 offen offset:1024 sc1
    buffer_load_dwordx4 v[36:39], v2, s[16:19], s47 offen offset:0 sc1
    buffer_load_dwordx4 v[40:43], v2, s[16:19], s47 offen offset:1024 sc1
    ds_read_b128 v[224:227], v17 offset:0
    ds_read_b128 v[228:231], v17 offset:8192
    ds_read_b128 v[232:235], v17 offset:16384
    ds_read_b128 v[236:239], v17 offset:24576
    ds_read_b128 v[240:243], v17 offset:1024
    ds_read_b128 v[244:247], v17 offset:9216
    ds_read_b128 v[248:251], v17 offset:17408
    ds_read_b128 v[252:255], v17 offset:25600
    s_lshl_b32 s55, s51, 11
    s_add_u32 s55, s55, 19922944
    v_mov_b32 v185, v18
    s_waitcnt lgkmcnt(4)
    s_nop 0
    v_pk_add_f32 v[224:225], v[224:225], v[228:229]
    v_pk_add_f32 v[232:233], v[232:233], v[236:237]
    v_pk_add_f32 v[226:227], v[226:227], v[230:231]
    v_pk_add_f32 v[234:235], v[234:235], v[238:239]
    v_pk_add_f32 v[224:225], v[224:225], v[232:233]
    v_pk_add_f32 v[226:227], v[226:227], v[234:235]
    s_waitcnt lgkmcnt(0)
    s_nop 0
    v_pk_add_f32 v[240:241], v[240:241], v[244:245]
    v_pk_add_f32 v[248:249], v[248:249], v[252:253]
    v_pk_add_f32 v[242:243], v[242:243], v[246:247]
    v_pk_add_f32 v[250:251], v[250:251], v[254:255]
    v_pk_add_f32 v[240:241], v[240:241], v[248:249]
    v_pk_add_f32 v[242:243], v[242:243], v[250:251]
    s_lshl_b32 s7, s45, 12
    v_add_u32 v7, s7, v2
    v_mov_b32_e64 v5, v7
    v_add_u32 v6, 32768, v7
    s_mov_b32 s36, 32768
    v_mov_b32 v112, 0
    v_mov_b32 v113, 0
    v_mov_b32 v114, 0
    v_mov_b32 v115, 0
    v_mov_b32 v116, 0
    v_mov_b32 v117, 0
    v_mov_b32 v118, 0
    v_mov_b32 v119, 0
    v_mov_b32 v120, 0
    v_mov_b32 v121, 0
    v_mov_b32 v122, 0
    v_mov_b32 v123, 0
    v_mov_b32 v124, 0
    v_mov_b32 v125, 0
    v_mov_b32 v126, 0
    v_mov_b32 v127, 0
    v_mov_b32 v144, 0
    v_mov_b32 v145, 0
    v_mov_b32 v146, 0
    v_mov_b32 v147, 0
    v_mov_b32 v128, 0
    v_mov_b32 v129, 0
    v_mov_b32 v130, 0
    v_mov_b32 v131, 0
    v_mov_b32 v132, 0
    v_mov_b32 v133, 0
    v_mov_b32 v134, 0
    v_mov_b32 v135, 0
    v_mov_b32 v136, 0
    v_mov_b32 v137, 0
    v_mov_b32 v138, 0
    v_mov_b32 v139, 0
    v_mov_b32 v140, 0
    v_mov_b32 v141, 0
    v_mov_b32 v142, 0
    v_mov_b32 v143, 0
    v_mov_b32 v148, 0
    v_mov_b32 v149, 0
    v_mov_b32 v150, 0
    v_mov_b32 v151, 0
    v_mov_b32 v104, 0
    v_mov_b32 v105, 0
    v_mov_b32 v106, 0
    v_mov_b32 v107, 0
    v_mov_b32 v108, 0
    v_mov_b32 v109, 0
    v_mov_b32 v110, 0
    v_mov_b32 v111, 0
    v_mov_b32 v72, 0
    v_mov_b32 v73, 0
    v_mov_b32 v74, 0
    v_mov_b32 v75, 0
    v_mov_b32 v76, 0
    v_mov_b32 v77, 0
    v_mov_b32 v78, 0
    v_mov_b32 v79, 0
    v_and_b32 v14, 8, v1
    v_cmp_eq_u32 vcc, 0, v14
    s_nop 1
    v_cndmask_b32 v204, 0, v44, vcc
    v_cndmask_b32 v205, 0, v45, vcc
    v_cndmask_b32 v206, 0, v46, vcc
    v_cndmask_b32 v207, 0, v47, vcc
    s_bitcmp1_b32 s2, 2
    s_cselect_b32 s8, s96, s30
    s_cselect_b32 s9, s97, s31
    s_mov_b32 s10, 0x200000
    s_mov_b32 s12, s98
    s_mov_b32 s13, s99
    s_mov_b32 s14, 0x800000
    s_add_u32 s37, s43, 12582912
    s_lshl_b32 s38, s32, 11
    s_add_u32 s38, s38, 19922944
    s_lshl_b32 s39, s32, 16
    s_lshl_b32 s7, s6, 10
    s_add_u32 s39, s39, s7
    s_add_u32 s39, s39, 16777216
    s_lshl_b32 s42, s32, 13
    s_lshl_b32 s7, s6, 5
    s_add_u32 s42, s42, s7
    s_add_u32 s42, s42, 18874368
    s_lshl_b32 s62, s34, 5
    s_add_u32 s62, s62, s32
    s_lshl_b32 s62, s62, 11
    s_add_u32 s62, s62, 20971520
    s_add_u32 s63, s62, 4194304
    s_add_u32 s64, s35, 2048
    v_lshrrev_b32 v15, 5, v1
    v_and_b32 v16, 31, v1
    v_lshlrev_b32_e64 v16, 8, v16
    v_lshl_add_u32 v8, v15, 4, v16
    s_and_b32 s68, s2, 3
    s_lshl_b32 s68, s68, 2
    s_bfe_u32 s7, s2, 0x20003
    s_add_u32 s68, s68, s7
    s_lshr_b32 s69, s2, 5
    v_lshrrev_b32 v14, 4, v1
    v_and_b32 v15, 15, v1
    v_lshlrev_b32 v16, 1, v14
    v_xor_b32 v16, v16, v15
    v_lshlrev_b32_e64 v16, 4, v16
    v_lshl_add_u32 v3, v14, 11, v16
    v_xor_b32 v4, 128, v3
    v_add_u32 v4, 7168, v4
    s_lshl_b32 s65, s6, 14
    s_lshl_b32 s7, s69, 8
    s_add_u32 s65, s65, s7
    s_add_u32 s66, s68, s69
    s_and_b32 s66, s66, 1
    s_lshl_b32 s66, s66, 3
    s_lshl_b32 s67, s6, 11
    s_branch ATT_61
ATT_60:
    s_cmp_lg_u32 s6, 0
    s_cbranch_scc1 GO_74
    v_and_b32 v16, 7, v1
    v_lshlrev_b32 v16, 2, v16
    s_mov_b32 s27, 0x40000
PL_75:
    buffer_load_dword v17, v16, s[16:19], s35 offen sc1
    s_sub_u32 s27, s27, 1
    s_cbranch_scc1 GO_74
    s_waitcnt vmcnt(0)
    v_cmp_ne_u32 vcc, 1, v17
    s_nop 4
    s_cbranch_vccz GO_74
    s_sleep 1
    s_branch PL_75
GO_74:
    s_barrier
    s_add_u32 m0, s44, 0
    s_nop 0
    s_nop 0
    buffer_load_dwordx4 v2, s[16:19], s40 offen offset:0 sc1 lds
    buffer_load_dwordx4 v2, s[16:19], s40 offen offset:1024 sc1 lds
    buffer_load_dwordx4 v2, s[16:19], s40 offen offset:2048 sc1 lds
    buffer_load_dwordx4 v2, s[16:19], s40 offen offset:3072 sc1 lds
    s_add_u32 s40, s40, 32768
    s_barrier
    s_nop 0
    buffer_load_dwordx4 v[28:31], v2, s[16:19], s46 offen offset:0 sc1
    buffer_load_dwordx4 v[32:35], v2, s[16:19], s46 offen offset:1024 sc1
    buffer_load_dwordx4 v[36:39], v2, s[16:19], s47 offen offset:0 sc1
    buffer_load_dwordx4 v[40:43], v2, s[16:19], s47 offen offset:1024 sc1
ATT_61:
    s_mov_b64 exec, -1
    s_waitcnt vmcnt(4)
    s_barrier
    s_cmp_eq_u32 s3, 0
    s_cselect_b32 s61, 2, 64
    s_nop 0
    ds_read_b128 v[48:51], v5 offset:0
    ds_read_b128 v[52:55], v5 offset:1024
    ds_read_b128 v[64:67], v5 offset:2048
    ds_read_b128 v[68:71], v5 offset:3072
    ds_read_b128 v[56:59], v5 offset:8192
    ds_read_b128 v[60:63], v5 offset:9216
    s_waitcnt vmcnt(2) lgkmcnt(4)
    v_mfma_f32_32x32x16_bf16 v[80:95], v[48:51], v[28:31], 0
    v_mfma_f32_32x32x16_bf16 v[80:95], v[52:55], v[32:35], v[80:95]
    s_add_u32 m0, s44, 32768
    s_nop 0
    buffer_load_dwordx4 v2, s[16:19], s40 offen offset:0 sc1 lds
    buffer_load_dwordx4 v2, s[16:19], s40 offen offset:1024 sc1 lds
    buffer_load_dwordx4 v2, s[16:19], s40 offen offset:2048 sc1 lds
    buffer_load_dwordx4 v2, s[16:19], s40 offen offset:3072 sc1 lds
    s_add_u32 s40, s40, 32768
    s_add_u32 m0, s44, 65536
    s_nop 0
    s_nop 0
    buffer_load_dwordx4 v2, s[16:19], s40 offen offset:0 sc1 lds
    buffer_load_dwordx4 v2, s[16:19], s40 offen offset:1024 sc1 lds
    buffer_load_dwordx4 v2, s[16:19], s40 offen offset:2048 sc1 lds
    buffer_load_dwordx4 v2, s[16:19], s40 offen offset:3072 sc1 lds
    s_add_u32 s40, s40, 32768
    s_add_u32 m0, s44, 98304
    s_mov_b32 s48, 0
    s_waitcnt vmcnt(8)
    s_cmp_lg_u32 s3, 0
    s_cbranch_scc1 ATLOOP_76
    v_exp_f32_e64 v80, v80
    v_exp_f32 v81, v81
    s_waitcnt lgkmcnt(0)
    v_smfmac_f32_32x32x32_bf16 v[128:143], v[76:79], v[104:111], v26
    ds_read_b128 v[72:75], v5 offset:10240
    ds_read_b128 v[76:79], v5 offset:11264
    v_exp_f32 v82, v82
    v_exp_f32 v83, v83
    v_exp_f32_e64 v84, v84
    v_smfmac_f32_16x16x64_bf16 v[148:151], v[204:207], v[104:111], v26
    v_exp_f32_e64 v85, v85
    v_mfma_f32_32x32x16_bf16 v[96:111], v[48:51], v[36:39], 0
    v_exp_f32 v86, v86
    v_exp_f32 v87, v87
    v_exp_f32_e64 v88, v88
    v_mfma_f32_32x32x16_bf16 v[96:111], v[52:55], v[40:43], v[96:111]
    ds_read_b128 v[48:51], v5 offset:16384
    ds_read_b128 v[52:55], v5 offset:17408
    v_exp_f32 v89, v89
    v_exp_f32 v90, v90
    v_exp_f32_e64 v91, v91
    v_smfmac_f32_32x32x32_bf16 v[112:127], v[64:67], v[80:87], v26
    buffer_store_dwordx4 v[208:211], v2, s[16:19], s54 offen offset:0 sc1
    v_exp_f32 v92, v92
    v_exp_f32 v93, v93
    v_exp_f32_e64 v94, v94
    v_smfmac_f32_16x16x64_bf16 v[144:147], v[204:207], v[80:87], v26
    v_exp_f32 v95, v95
    v_exp_f32 v96, v96
    v_exp_f32_e64 v97, v97
    v_smfmac_f32_32x32x32_bf16 v[112:127], v[68:71], v[88:95], v26
    v_exp_f32 v98, v98
    v_exp_f32 v99, v99
    v_exp_f32_e64 v100, v100
    v_smfmac_f32_16x16x64_bf16 v[144:147], v[204:207], v[88:95], v26
    v_exp_f32_e64 v101, v101
    v_mfma_f32_32x32x16_bf16 v[80:95], v[56:59], v[28:31], 0
    v_exp_f32 v102, v102
    v_exp_f32 v103, v103
    v_exp_f32_e64 v104, v104
    v_mfma_f32_32x32x16_bf16 v[80:95], v[60:63], v[32:35], v[80:95]
    v_exp_f32 v105, v105
    v_exp_f32 v106, v106
    v_exp_f32_e64 v107, v107
    v_smfmac_f32_32x32x32_bf16 v[128:143], v[64:67], v[96:103], v26
    buffer_store_dwordx4 v[212:215], v2, s[16:19], s54 offen offset:1024 sc1
    v_exp_f32 v108, v108
    v_exp_f32 v109, v109
    v_exp_f32_e64 v110, v110
    v_smfmac_f32_16x16x64_bf16 v[148:151], v[204:207], v[96:103], v26
    v_exp_f32 v111, v111
    v_exp_f32 v80, v80
    v_exp_f32 v81, v81
    s_waitcnt lgkmcnt(0)
    v_smfmac_f32_32x32x32_bf16 v[128:143], v[68:71], v[104:111], v26
    ds_read_b128 v[64:67], v5 offset:18432
    ds_read_b128 v[68:71], v5 offset:19456
    v_exp_f32 v82, v82
    v_exp_f32 v83, v83
    v_exp_f32_e64 v84, v84
    v_smfmac_f32_16x16x64_bf16 v[148:151], v[204:207], v[104:111], v26
    v_exp_f32_e64 v85, v85
    v_mfma_f32_32x32x16_bf16 v[96:111], v[56:59], v[36:39], 0
    v_exp_f32 v86, v86
    v_exp_f32 v87, v87
    v_exp_f32_e64 v88, v88
    v_mfma_f32_32x32x16_bf16 v[96:111], v[60:63], v[40:43], v[96:111]
    ds_read_b128 v[56:59], v5 offset:24576
    ds_read_b128 v[60:63], v5 offset:25600
    v_exp_f32 v89, v89
    v_exp_f32 v90, v90
    v_exp_f32_e64 v91, v91
    v_smfmac_f32_32x32x32_bf16 v[112:127], v[72:75], v[80:87], v26
    buffer_store_dwordx4 v[216:219], v2, s[16:19], s54 offen offset:2048 sc1
    v_exp_f32 v92, v92
    v_exp_f32 v93, v93
    v_exp_f32_e64 v94, v94
    v_smfmac_f32_16x16x64_bf16 v[144:147], v[204:207], v[80:87], v26
    s_setprio 0
    v_exp_f32 v95, v95
    v_exp_f32 v96, v96
    v_exp_f32 v97, v97
    v_smfmac_f32_32x32x32_bf16 v[112:127], v[76:79], v[88:95], v26
    v_exp_f32 v98, v98
    v_exp_f32 v99, v99
    v_exp_f32_e64 v100, v100
    v_smfmac_f32_16x16x64_bf16 v[144:147], v[204:207], v[88:95], v26
    v_exp_f32_e64 v101, v101
    v_mfma_f32_32x32x16_bf16 v[80:95], v[48:51], v[28:31], 0
    v_exp_f32 v102, v102
    v_exp_f32 v103, v103
    v_exp_f32_e64 v104, v104
    v_mfma_f32_32x32x16_bf16 v[80:95], v[52:55], v[32:35], v[80:95]
    v_exp_f32 v105, v105
    v_exp_f32 v106, v106
    v_exp_f32_e64 v107, v107
    v_smfmac_f32_32x32x32_bf16 v[128:143], v[72:75], v[96:103], v26
    buffer_store_dwordx4 v[220:223], v2, s[16:19], s54 offen offset:3072 sc1
    v_exp_f32 v108, v108
    v_exp_f32 v109, v109
    v_exp_f32_e64 v110, v110
    v_smfmac_f32_16x16x64_bf16 v[148:151], v[204:207], v[96:103], v26
    v_exp_f32 v111, v111
    v_exp_f32 v80, v80
    v_exp_f32 v81, v81
    s_waitcnt lgkmcnt(0)
    v_smfmac_f32_32x32x32_bf16 v[128:143], v[76:79], v[104:111], v26
    ds_read_b128 v[72:75], v5 offset:26624
    ds_read_b128 v[76:79], v5 offset:27648
    v_exp_f32 v82, v82
    v_exp_f32 v83, v83
    v_exp_f32_e64 v84, v84
    v_smfmac_f32_16x16x64_bf16 v[148:151], v[204:207], v[104:111], v26
    v_exp_f32_e64 v85, v85
    v_mfma_f32_32x32x16_bf16 v[96:111], v[48:51], v[36:39], 0
    v_exp_f32 v86, v86
    v_exp_f32 v87, v87
    v_exp_f32_e64 v88, v88
    v_mfma_f32_32x32x16_bf16 v[96:111], v[52:55], v[40:43], v[96:111]
    s_waitcnt vmcnt(8)
    s_barrier
    s_setprio 1
    ds_read_b128 v[48:51], v6 offset:0
    ds_read_b128 v[52:55], v6 offset:1024
    v_exp_f32 v89, v89
    v_exp_f32 v90, v90
    v_exp_f32 v91, v91
    v_smfmac_f32_32x32x32_bf16 v[112:127], v[64:67], v[80:87], v26
    buffer_store_dwordx4 v[224:227], v2, s[16:19], s56 offen offset:0 sc1
    buffer_load_dwordx4 v2, s[16:19], s40 offen offset:0 sc1 lds
    v_exp_f32 v92, v92
    v_exp_f32 v93, v93
    v_exp_f32_e64 v94, v94
    v_smfmac_f32_16x16x64_bf16 v[144:147], v[204:207], v[80:87], v26
    v_exp_f32 v95, v95
    v_exp_f32 v96, v96
    v_exp_f32_e64 v97, v97
    v_smfmac_f32_32x32x32_bf16 v[112:127], v[68:71], v[88:95], v26
    v_exp_f32 v98, v98
    v_exp_f32 v99, v99
    v_exp_f32_e64 v100, v100
    v_smfmac_f32_16x16x64_bf16 v[144:147], v[204:207], v[88:95], v26
    v_exp_f32_e64 v101, v101
    v_mfma_f32_32x32x16_bf16 v[80:95], v[56:59], v[28:31], 0
    v_exp_f32 v102, v102
    v_exp_f32 v103, v103
    v_exp_f32_e64 v104, v104
    v_mfma_f32_32x32x16_bf16 v[80:95], v[60:63], v[32:35], v[80:95]
    v_exp_f32 v105, v105
    v_exp_f32 v106, v106
    v_exp_f32_e64 v107, v107
    v_smfmac_f32_32x32x32_bf16 v[128:143], v[64:67], v[96:103], v26
    buffer_store_dwordx4 v[240:243], v2, s[16:19], s56 offen offset:1024 sc1
    buffer_load_dwordx4 v2, s[16:19], s40 offen offset:1024 sc1 lds
    v_exp_f32 v108, v108
    v_exp_f32 v109, v109
    v_exp_f32_e64 v110, v110
    v_smfmac_f32_16x16x64_bf16 v[148:151], v[204:207], v[96:103], v26
    v_exp_f32 v111, v111
    v_exp_f32 v80, v80
    v_exp_f32 v81, v81
    s_waitcnt lgkmcnt(0)
    v_smfmac_f32_32x32x32_bf16 v[128:143], v[68:71], v[104:111], v26
    ds_read_b128 v[64:67], v6 offset:2048
    ds_read_b128 v[68:71], v6 offset:3072
    v_exp_f32 v82, v82
    v_exp_f32 v83, v83
    v_exp_f32_e64 v84, v84
    v_smfmac_f32_16x16x64_bf16 v[148:151], v[204:207], v[104:111], v26
    v_exp_f32_e64 v85, v85
    v_mfma_f32_32x32x16_bf16 v[96:111], v[56:59], v[36:39], 0
    v_exp_f32 v86, v86
    v_exp_f32 v87, v87
    v_exp_f32_e64 v88, v88
    v_mfma_f32_32x32x16_bf16 v[96:111], v[60:63], v[40:43], v[96:111]
    ds_read_b128 v[56:59], v6 offset:8192
    ds_read_b128 v[60:63], v6 offset:9216
    v_exp_f32 v89, v89
    v_exp_f32 v90, v90
    v_exp_f32_e64 v91, v91
    v_smfmac_f32_32x32x32_bf16 v[112:127], v[72:75], v[80:87], v26
    buffer_store_dword v184, v185, s[16:19], s57 offen sc1
    buffer_load_dwordx4 v2, s[16:19], s40 offen offset:2048 sc1 lds
    v_exp_f32 v92, v92
    v_exp_f32 v93, v93
    v_exp_f32_e64 v94, v94
    v_smfmac_f32_16x16x64_bf16 v[144:147], v[204:207], v[80:87], v26
    v_exp_f32 v95, v95
    v_exp_f32 v96, v96
    v_exp_f32_e64 v97, v97
    v_smfmac_f32_32x32x32_bf16 v[112:127], v[76:79], v[88:95], v26
    v_exp_f32 v98, v98
    v_exp_f32 v99, v99
    v_exp_f32_e64 v100, v100
    v_smfmac_f32_16x16x64_bf16 v[144:147], v[204:207], v[88:95], v26
    v_exp_f32_e64 v101, v101
    v_mfma_f32_32x32x16_bf16 v[80:95], v[48:51], v[28:31], 0
    v_exp_f32 v102, v102
    v_exp_f32 v103, v103
    v_exp_f32_e64 v104, v104
    v_mfma_f32_32x32x16_bf16 v[80:95], v[52:55], v[32:35], v[80:95]
    v_exp_f32 v105, v105
    v_exp_f32 v106, v106
    v_exp_f32_e64 v107, v107
    v_smfmac_f32_32x32x32_bf16 v[128:143], v[72:75], v[96:103], v26
    s_cmp_lg_u32 s52, 0
    s_cbranch_scc1 NOPUB_73
    buffer_store_dwordx4 v[176:179], v2, s[16:19], s55 offen offset:0 sc1
    buffer_store_dwordx4 v[180:183], v2, s[16:19], s55 offen offset:1024 sc1
NOPUB_73:
    buffer_load_dwordx4 v2, s[16:19], s40 offen offset:3072 sc1 lds
    s_add_u32 s40, s40, 32768
    s_add_u32 s7, m0, 32768
    s_and_b32 m0, s7, 131071
    v_exp_f32 v108, v108
    v_exp_f32 v109, v109
    v_exp_f32_e64 v110, v110
    v_smfmac_f32_16x16x64_bf16 v[148:151], v[204:207], v[96:103], v26
    v_exp_f32 v111, v111
    v_mov_b32 v5, v6
    s_add_u32 s36, s36, 32768
    s_and_b32 s36, s36, 131071
    v_add_u32 v6, s36, v7
    s_mov_b32 s48, 1
.p2align 6
ATLOOP_76:
    v_exp_f32_e64 v80, v80
    v_exp_f32 v81, v81
    s_waitcnt lgkmcnt(0)
    v_smfmac_f32_32x32x32_bf16 v[128:143], v[76:79], v[104:111], v26
    ds_read_b128 v[72:75], v5 offset:10240
    ds_read_b128 v[76:79], v5 offset:11264
    v_exp_f32 v82, v82
    v_exp_f32 v83, v83
    v_exp_f32_e64 v84, v84
    v_smfmac_f32_16x16x64_bf16 v[148:151], v[204:207], v[104:111], v26
    v_exp_f32_e64 v85, v85
    v_mfma_f32_32x32x16_bf16 v[96:111], v[48:51], v[36:39], 0
    v_exp_f32 v86, v86
    v_exp_f32 v87, v87
    v_exp_f32_e64 v88, v88
    v_mfma_f32_32x32x16_bf16 v[96:111], v[52:55], v[40:43], v[96:111]
    ds_read_b128 v[48:51], v5 offset:16384
    ds_read_b128 v[52:55], v5 offset:17408
    v_exp_f32 v89, v89
    v_exp_f32 v90, v90
    v_exp_f32_e64 v91, v91
    v_smfmac_f32_32x32x32_bf16 v[112:127], v[64:67], v[80:87], v26
    v_exp_f32 v92, v92
    v_exp_f32 v93, v93
    v_exp_f32_e64 v94, v94
    v_smfmac_f32_16x16x64_bf16 v[144:147], v[204:207], v[80:87], v26
    v_exp_f32 v95, v95
    v_exp_f32 v96, v96
    v_exp_f32_e64 v97, v97
    v_smfmac_f32_32x32x32_bf16 v[112:127], v[68:71], v[88:95], v26
    v_exp_f32 v98, v98
    v_exp_f32 v99, v99
    v_exp_f32_e64 v100, v100
    v_smfmac_f32_16x16x64_bf16 v[144:147], v[204:207], v[88:95], v26
    v_exp_f32_e64 v101, v101
    v_mfma_f32_32x32x16_bf16 v[80:95], v[56:59], v[28:31], 0
    v_exp_f32 v102, v102
    v_exp_f32 v103, v103
    v_exp_f32_e64 v104, v104
    v_mfma_f32_32x32x16_bf16 v[80:95], v[60:63], v[32:35], v[80:95]
    v_exp_f32 v105, v105
    v_exp_f32 v106, v106
    v_exp_f32_e64 v107, v107
    v_smfmac_f32_32x32x32_bf16 v[128:143], v[64:67], v[96:103], v26
    v_exp_f32 v108, v108
    v_exp_f32 v109, v109
    v_exp_f32_e64 v110, v110
    v_smfmac_f32_16x16x64_bf16 v[148:151], v[204:207], v[96:103], v26
    v_exp_f32 v111, v111
    v_exp_f32 v80, v80
    v_exp_f32 v81, v81
    s_waitcnt lgkmcnt(0)
    v_smfmac_f32_32x32x32_bf16 v[128:143], v[68:71], v[104:111], v26
    ds_read_b128 v[64:67], v5 offset:18432
    ds_read_b128 v[68:71], v5 offset:19456
    v_exp_f32 v82, v82
    v_exp_f32 v83, v83
    v_exp_f32_e64 v84, v84
    v_smfmac_f32_16x16x64_bf16 v[148:151], v[204:207], v[104:111], v26
    v_exp_f32_e64 v85, v85
    v_mfma_f32_32x32x16_bf16 v[96:111], v[56:59], v[36:39], 0
    v_exp_f32 v86, v86
    v_exp_f32 v87, v87
    v_exp_f32_e64 v88, v88
    v_mfma_f32_32x32x16_bf16 v[96:111], v[60:63], v[40:43], v[96:111]
    ds_read_b128 v[56:59], v5 offset:24576
    ds_read_b128 v[60:63], v5 offset:25600
    v_exp_f32 v89, v89
    v_exp_f32 v90, v90
    v_exp_f32_e64 v91, v91
    v_smfmac_f32_32x32x32_bf16 v[112:127], v[72:75], v[80:87], v26
    v_exp_f32 v92, v92
    v_exp_f32 v93, v93
    v_exp_f32_e64 v94, v94
    v_smfmac_f32_16x16x64_bf16 v[144:147], v[204:207], v[80:87], v26
    s_setprio 0
    v_exp_f32 v95, v95
    v_exp_f32 v96, v96
    v_exp_f32 v97, v97
    v_smfmac_f32_32x32x32_bf16 v[112:127], v[76:79], v[88:95], v26
    v_exp_f32 v98, v98
    v_exp_f32 v99, v99
    v_exp_f32_e64 v100, v100
    v_smfmac_f32_16x16x64_bf16 v[144:147], v[204:207], v[88:95], v26
    v_exp_f32_e64 v101, v101
    v_mfma_f32_32x32x16_bf16 v[80:95], v[48:51], v[28:31], 0
    v_exp_f32 v102, v102
    v_exp_f32 v103, v103
    v_exp_f32_e64 v104, v104
    v_mfma_f32_32x32x16_bf16 v[80:95], v[52:55], v[32:35], v[80:95]
    v_exp_f32 v105, v105
    v_exp_f32 v106, v106
    v_exp_f32_e64 v107, v107
    v_smfmac_f32_32x32x32_bf16 v[128:143], v[72:75], v[96:103], v26
    s_cmp_eq_u32 s48, s61
    s_cbranch_scc1 DRA_80
DRR_81:
    v_exp_f32 v108, v108
    v_exp_f32 v109, v109
    v_exp_f32_e64 v110, v110
    v_smfmac_f32_16x16x64_bf16 v[148:151], v[204:207], v[96:103], v26
    v_exp_f32 v111, v111
    v_exp_f32 v80, v80
    v_exp_f32 v81, v81
    s_waitcnt lgkmcnt(0)
    v_smfmac_f32_32x32x32_bf16 v[128:143], v[76:79], v[104:111], v26
    ds_read_b128 v[72:75], v5 offset:26624
    ds_read_b128 v[76:79], v5 offset:27648
    v_exp_f32 v82, v82
    v_exp_f32 v83, v83
    v_exp_f32_e64 v84, v84
    v_smfmac_f32_16x16x64_bf16 v[148:151], v[204:207], v[104:111], v26
    v_exp_f32_e64 v85, v85
    v_mfma_f32_32x32x16_bf16 v[96:111], v[48:51], v[36:39], 0
    v_exp_f32 v86, v86
    v_exp_f32 v87, v87
    v_exp_f32_e64 v88, v88
    v_mfma_f32_32x32x16_bf16 v[96:111], v[52:55], v[40:43], v[96:111]
    s_waitcnt vmcnt(4)
    s_barrier
    s_setprio 1
    ds_read_b128 v[48:51], v6 offset:0
    ds_read_b128 v[52:55], v6 offset:1024
    v_exp_f32 v89, v89
    v_exp_f32 v90, v90
    v_exp_f32 v91, v91
    v_smfmac_f32_32x32x32_bf16 v[112:127], v[64:67], v[80:87], v26
    buffer_load_dwordx4 v2, s[16:19], s40 offen offset:0 sc1 lds
    s_cmp_eq_u32 s48, s61
    s_cbranch_scc1 PUBA_78
PUBR_79:
    v_exp_f32 v92, v92
    v_exp_f32 v93, v93
    v_exp_f32_e64 v94, v94
    v_smfmac_f32_16x16x64_bf16 v[144:147], v[204:207], v[80:87], v26
    v_exp_f32 v95, v95
    v_exp_f32 v96, v96
    v_exp_f32_e64 v97, v97
    v_smfmac_f32_32x32x32_bf16 v[112:127], v[68:71], v[88:95], v26
    v_exp_f32 v98, v98
    v_exp_f32 v99, v99
    v_exp_f32_e64 v100, v100
    v_smfmac_f32_16x16x64_bf16 v[144:147], v[204:207], v[88:95], v26
    v_exp_f32_e64 v101, v101
    v_mfma_f32_32x32x16_bf16 v[80:95], v[56:59], v[28:31], 0
    v_exp_f32 v102, v102
    v_exp_f32 v103, v103
    v_exp_f32_e64 v104, v104
    v_mfma_f32_32x32x16_bf16 v[80:95], v[60:63], v[32:35], v[80:95]
    v_exp_f32 v105, v105
    v_exp_f32 v106, v106
    v_exp_f32_e64 v107, v107
    v_smfmac_f32_32x32x32_bf16 v[128:143], v[64:67], v[96:103], v26
    buffer_load_dwordx4 v2, s[16:19], s40 offen offset:1024 sc1 lds
    v_exp_f32 v108, v108
    v_exp_f32 v109, v109
    v_exp_f32_e64 v110, v110
    v_smfmac_f32_16x16x64_bf16 v[148:151], v[204:207], v[96:103], v26
    v_exp_f32 v111, v111
    v_exp_f32 v80, v80
    v_exp_f32 v81, v81
    s_waitcnt lgkmcnt(0)
    v_smfmac_f32_32x32x32_bf16 v[128:143], v[68:71], v[104:111], v26
    ds_read_b128 v[64:67], v6 offset:2048
    ds_read_b128 v[68:71], v6 offset:3072
    v_exp_f32 v82, v82
    v_exp_f32 v83, v83
    v_exp_f32_e64 v84, v84
    v_smfmac_f32_16x16x64_bf16 v[148:151], v[204:207], v[104:111], v26
    v_exp_f32_e64 v85, v85
    v_mfma_f32_32x32x16_bf16 v[96:111], v[56:59], v[36:39], 0
    v_exp_f32 v86, v86
    v_exp_f32 v87, v87
    v_exp_f32_e64 v88, v88
    v_mfma_f32_32x32x16_bf16 v[96:111], v[60:63], v[40:43], v[96:111]
    ds_read_b128 v[56:59], v6 offset:8192
    ds_read_b128 v[60:63], v6 offset:9216
    v_exp_f32 v89, v89
    v_exp_f32 v90, v90
    v_exp_f32_e64 v91, v91
    v_smfmac_f32_32x32x32_bf16 v[112:127], v[72:75], v[80:87], v26
    buffer_load_dwordx4 v2, s[16:19], s40 offen offset:2048 sc1 lds
    v_exp_f32 v92, v92
    v_exp_f32 v93, v93
    v_exp_f32_e64 v94, v94
    v_smfmac_f32_16x16x64_bf16 v[144:147], v[204:207], v[80:87], v26
    v_exp_f32 v95, v95
    v_exp_f32 v96, v96
    v_exp_f32_e64 v97, v97
    v_smfmac_f32_32x32x32_bf16 v[112:127], v[76:79], v[88:95], v26
    v_exp_f32 v98, v98
    v_exp_f32 v99, v99
    v_exp_f32_e64 v100, v100
    v_smfmac_f32_16x16x64_bf16 v[144:147], v[204:207], v[88:95], v26
    v_exp_f32_e64 v101, v101
    v_mfma_f32_32x32x16_bf16 v[80:95], v[48:51], v[28:31], 0
    v_exp_f32 v102, v102
    v_exp_f32 v103, v103
    v_exp_f32_e64 v104, v104
    v_mfma_f32_32x32x16_bf16 v[80:95], v[52:55], v[32:35], v[80:95]
    v_exp_f32 v105, v105
    v_exp_f32 v106, v106
    v_exp_f32_e64 v107, v107
    v_smfmac_f32_32x32x32_bf16 v[128:143], v[72:75], v[96:103], v26
    buffer_load_dwordx4 v2, s[16:19], s40 offen offset:3072 sc1 lds
    s_add_u32 s40, s40, 32768
    s_add_u32 s7, m0, 32768
    s_and_b32 m0, s7, 131071
    v_exp_f32 v108, v108
    v_exp_f32 v109, v109
    v_exp_f32_e64 v110, v110
    v_smfmac_f32_16x16x64_bf16 v[148:151], v[204:207], v[96:103], v26
    v_exp_f32 v111, v111
    v_mov_b32 v5, v6
    s_add_u32 s36, s36, 32768
    s_and_b32 s36, s36, 131071
    v_add_u32 v6, s36, v7
    s_add_u32 s48, s48, 1
    s_cmp_lt_u32 s48, 5
    s_cbranch_scc1 ATLOOP_76
    v_exp_f32_e64 v80, v80
    v_exp_f32 v81, v81
    s_waitcnt lgkmcnt(0)
    v_smfmac_f32_32x32x32_bf16 v[128:143], v[76:79], v[104:111], v26
    ds_read_b128 v[72:75], v5 offset:10240
    ds_read_b128 v[76:79], v5 offset:11264
    v_exp_f32 v82, v82
    v_exp_f32 v83, v83
    v_exp_f32_e64 v84, v84
    v_smfmac_f32_16x16x64_bf16 v[148:151], v[204:207], v[104:111], v26
    v_exp_f32_e64 v85, v85
    v_mfma_f32_32x32x16_bf16 v[96:111], v[48:51], v[36:39], 0
    v_exp_f32 v86, v86
    v_exp_f32 v87, v87
    v_exp_f32_e64 v88, v88
    v_mfma_f32_32x32x16_bf16 v[96:111], v[52:55], v[40:43], v[96:111]
    ds_read_b128 v[48:51], v5 offset:16384
    ds_read_b128 v[52:55], v5 offset:17408
    v_exp_f32 v89, v89
    v_exp_f32 v90, v90
    v_exp_f32_e64 v91, v91
    v_smfmac_f32_32x32x32_bf16 v[112:127], v[64:67], v[80:87], v26
    v_exp_f32 v92, v92
    v_exp_f32 v93, v93
    v_exp_f32_e64 v94, v94
    v_smfmac_f32_16x16x64_bf16 v[144:147], v[204:207], v[80:87], v26
    v_exp_f32 v95, v95
    v_exp_f32 v96, v96
    v_exp_f32_e64 v97, v97
    v_smfmac_f32_32x32x32_bf16 v[112:127], v[68:71], v[88:95], v26
    v_exp_f32 v98, v98
    v_exp_f32 v99, v99
    v_exp_f32_e64 v100, v100
    v_smfmac_f32_16x16x64_bf16 v[144:147], v[204:207], v[88:95], v26
    v_exp_f32_e64 v101, v101
    v_mfma_f32_32x32x16_bf16 v[80:95], v[56:59], v[28:31], 0
    v_exp_f32 v102, v102
    v_exp_f32 v103, v103
    v_exp_f32_e64 v104, v104
    v_mfma_f32_32x32x16_bf16 v[80:95], v[60:63], v[32:35], v[80:95]
    v_exp_f32 v105, v105
    v_exp_f32 v106, v106
    v_exp_f32_e64 v107, v107
    v_smfmac_f32_32x32x32_bf16 v[128:143], v[64:67], v[96:103], v26
    v_exp_f32 v108, v108
    v_exp_f32 v109, v109
    v_exp_f32_e64 v110, v110
    v_smfmac_f32_16x16x64_bf16 v[148:151], v[204:207], v[96:103], v26
    v_exp_f32 v111, v111
    v_exp_f32 v80, v80
    v_exp_f32 v81, v81
    s_waitcnt lgkmcnt(0)
    v_smfmac_f32_32x32x32_bf16 v[128:143], v[68:71], v[104:111], v26
    ds_read_b128 v[64:67], v5 offset:18432
    ds_read_b128 v[68:71], v5 offset:19456
    v_exp_f32 v82, v82
    v_exp_f32 v83, v83
    v_exp_f32_e64 v84, v84
    v_smfmac_f32_16x16x64_bf16 v[148:151], v[204:207], v[104:111], v26
    v_exp_f32_e64 v85, v85
    v_mfma_f32_32x32x16_bf16 v[96:111], v[56:59], v[36:39], 0
    v_exp_f32 v86, v86
    v_exp_f32 v87, v87
    v_exp_f32_e64 v88, v88
    v_mfma_f32_32x32x16_bf16 v[96:111], v[60:63], v[40:43], v[96:111]
    ds_read_b128 v[56:59], v5 offset:24576
    ds_read_b128 v[60:63], v5 offset:25600
    v_exp_f32 v89, v89
    v_exp_f32 v90, v90
    v_exp_f32_e64 v91, v91
    v_smfmac_f32_32x32x32_bf16 v[112:127], v[72:75], v[80:87], v26
    v_exp_f32 v92, v92
    v_exp_f32 v93, v93
    v_exp_f32_e64 v94, v94
    v_smfmac_f32_16x16x64_bf16 v[144:147], v[204:207], v[80:87], v26
    s_setprio 0
    v_exp_f32 v95, v95
    v_exp_f32 v96, v96
    v_exp_f32 v97, v97
    v_smfmac_f32_32x32x32_bf16 v[112:127], v[76:79], v[88:95], v26
    v_exp_f32 v98, v98
    v_exp_f32 v99, v99
    v_exp_f32_e64 v100, v100
    v_smfmac_f32_16x16x64_bf16 v[144:147], v[204:207], v[88:95], v26
    v_exp_f32_e64 v101, v101
    v_mfma_f32_32x32x16_bf16 v[80:95], v[48:51], v[28:31], 0
    v_exp_f32 v102, v102
    v_exp_f32 v103, v103
    v_exp_f32_e64 v104, v104
    v_mfma_f32_32x32x16_bf16 v[80:95], v[52:55], v[32:35], v[80:95]
    v_exp_f32 v105, v105
    v_exp_f32 v106, v106
    v_exp_f32_e64 v107, v107
    v_smfmac_f32_32x32x32_bf16 v[128:143], v[72:75], v[96:103], v26
    v_exp_f32 v108, v108
    v_exp_f32 v109, v109
    v_exp_f32_e64 v110, v110
    v_smfmac_f32_16x16x64_bf16 v[148:151], v[204:207], v[96:103], v26
    v_exp_f32 v111, v111
    v_exp_f32 v80, v80
    v_exp_f32 v81, v81
    s_waitcnt lgkmcnt(0)
    v_smfmac_f32_32x32x32_bf16 v[128:143], v[76:79], v[104:111], v26
    ds_read_b128 v[72:75], v5 offset:26624
    ds_read_b128 v[76:79], v5 offset:27648
    v_exp_f32 v82, v82
    v_exp_f32 v83, v83
    v_exp_f32_e64 v84, v84
    v_smfmac_f32_16x16x64_bf16 v[148:151], v[204:207], v[104:111], v26
    v_exp_f32_e64 v85, v85
    v_mfma_f32_32x32x16_bf16 v[96:111], v[48:51], v[36:39], 0
    v_exp_f32 v86, v86
    v_exp_f32 v87, v87
    v_exp_f32_e64 v88, v88
    v_mfma_f32_32x32x16_bf16 v[96:111], v[52:55], v[40:43], v[96:111]
    s_cmp_lg_u32 s6, 0
    s_cbranch_scc1 GO_84
    v_and_b32 v16, 7, v1
    v_lshlrev_b32 v16, 2, v16
    s_mov_b32 s27, 0x40000
PL_85:
    buffer_load_dword v17, v16, s[16:19], s64 offen sc1
    s_sub_u32 s27, s27, 1
    s_cbranch_scc1 GO_84
    s_waitcnt vmcnt(0)
    v_cmp_ne_u32 vcc, 1, v17
    s_nop 4
    s_cbranch_vccz GO_84
    s_sleep 1
    s_branch PL_85
GO_84:
    s_waitcnt vmcnt(4)
    s_barrier
    s_setprio 1
    ds_read_b128 v[48:51], v6 offset:0
    ds_read_b128 v[52:55], v6 offset:1024
    v_exp_f32 v89, v89
    v_exp_f32 v90, v90
    v_exp_f32 v91, v91
    v_smfmac_f32_32x32x32_bf16 v[112:127], v[64:67], v[80:87], v26
    buffer_load_dwordx4 v[168:171], v2, s[16:19], s39 offen sc1
    s_add_u32 s39, s39, 8192
    buffer_load_dwordx4 v[172:175], v2, s[16:19], s39 offen sc1
    s_add_u32 s39, s39, 8192
    v_exp_f32 v92, v92
    v_exp_f32 v93, v93
    v_exp_f32_e64 v94, v94
    v_smfmac_f32_16x16x64_bf16 v[144:147], v[204:207], v[80:87], v26
    v_exp_f32 v95, v95
    v_exp_f32 v96, v96
    v_exp_f32_e64 v97, v97
    v_smfmac_f32_32x32x32_bf16 v[112:127], v[68:71], v[88:95], v26
    v_exp_f32 v98, v98
    v_exp_f32 v99, v99
    v_exp_f32_e64 v100, v100
    v_smfmac_f32_16x16x64_bf16 v[144:147], v[204:207], v[88:95], v26
    v_exp_f32_e64 v101, v101
    v_mfma_f32_32x32x16_bf16 v[80:95], v[56:59], v[28:31], 0
    v_exp_f32 v102, v102
    v_exp_f32 v103, v103
    v_exp_f32_e64 v104, v104
    v_mfma_f32_32x32x16_bf16 v[80:95], v[60:63], v[32:35], v[80:95]
    v_exp_f32 v105, v105
    v_exp_f32 v106, v106
    v_exp_f32_e64 v107, v107
    v_smfmac_f32_32x32x32_bf16 v[128:143], v[64:67], v[96:103], v26
    buffer_load_dwordx4 v[176:179], v2, s[16:19], s39 offen sc1
    s_add_u32 s39, s39, 8192
    buffer_load_dwordx4 v[180:183], v2, s[16:19], s39 offen sc1
    s_add_u32 s39, s39, 8192
    v_exp_f32 v108, v108
    v_exp_f32 v109, v109
    v_exp_f32_e64 v110, v110
    v_smfmac_f32_16x16x64_bf16 v[148:151], v[204:207], v[96:103], v26
    v_exp_f32 v111, v111
    v_exp_f32 v80, v80
    v_exp_f32 v81, v81
    s_waitcnt lgkmcnt(0)
    v_smfmac_f32_32x32x32_bf16 v[128:143], v[68:71], v[104:111], v26
    ds_read_b128 v[64:67], v6 offset:2048
    ds_read_b128 v[68:71], v6 offset:3072
    v_exp_f32 v82, v82
    v_exp_f32 v83, v83
    v_exp_f32_e64 v84, v84
    v_smfmac_f32_16x16x64_bf16 v[148:151], v[204:207], v[104:111], v26
    v_exp_f32_e64 v85, v85
    v_mfma_f32_32x32x16_bf16 v[96:111], v[56:59], v[36:39], 0
    v_exp_f32 v86, v86
    v_exp_f32 v87, v87
    v_exp_f32_e64 v88, v88
    v_mfma_f32_32x32x16_bf16 v[96:111], v[60:63], v[40:43], v[96:111]
    ds_read_b128 v[56:59], v6 offset:8192
    ds_read_b128 v[60:63], v6 offset:9216
    v_exp_f32 v89, v89
    v_exp_f32 v90, v90
    v_exp_f32_e64 v91, v91
    v_smfmac_f32_32x32x32_bf16 v[112:127], v[72:75], v[80:87], v26
    buffer_load_dwordx4 v[184:187], v2, s[16:19], s39 offen sc1
    s_add_u32 s39, s39, 8192
    buffer_load_dwordx4 v[188:191], v2, s[16:19], s39 offen sc1
    s_add_u32 s39, s39, 8192
    v_exp_f32 v92, v92
    v_exp_f32 v93, v93
    v_exp_f32_e64 v94, v94
    v_smfmac_f32_16x16x64_bf16 v[144:147], v[204:207], v[80:87], v26
    v_exp_f32 v95, v95
    v_exp_f32 v96, v96
    v_exp_f32_e64 v97, v97
    v_smfmac_f32_32x32x32_bf16 v[112:127], v[76:79], v[88:95], v26
    v_exp_f32 v98, v98
    v_exp_f32 v99, v99
    v_exp_f32_e64 v100, v100
    v_smfmac_f32_16x16x64_bf16 v[144:147], v[204:207], v[88:95], v26
    v_exp_f32_e64 v101, v101
    v_mfma_f32_32x32x16_bf16 v[80:95], v[48:51], v[28:31], 0
    v_exp_f32 v102, v102
    v_exp_f32 v103, v103
    v_exp_f32_e64 v104, v104
    v_mfma_f32_32x32x16_bf16 v[80:95], v[52:55], v[32:35], v[80:95]
    v_exp_f32 v105, v105
    v_exp_f32 v106, v106
    v_exp_f32_e64 v107, v107
    v_smfmac_f32_32x32x32_bf16 v[128:143], v[72:75], v[96:103], v26
    buffer_load_dwordx4 v[192:195], v2, s[16:19], s39 offen sc1
    s_add_u32 s39, s39, 8192
    buffer_load_dwordx4 v[196:199], v2, s[16:19], s39 offen sc1
    s_add_u32 s39, s39, 8192
    buffer_load_dwordx4 v[200:203], v8, s[16:19], s42 offen sc1
    v_exp_f32 v108, v108
    v_exp_f32 v109, v109
    v_exp_f32_e64 v110, v110
    v_smfmac_f32_16x16x64_bf16 v[148:151], v[204:207], v[96:103], v26
    v_exp_f32 v111, v111
    v_mov_b32 v5, v6
    s_add_u32 s36, s36, 32768
    s_and_b32 s36, s36, 131071
    v_add_u32 v6, s36, v7
    v_exp_f32 v80, v80
    v_exp_f32 v81, v81
    s_waitcnt lgkmcnt(0)
    v_smfmac_f32_32x32x32_bf16 v[128:143], v[76:79], v[104:111], v26
    ds_read_b128 v[72:75], v5 offset:10240
    ds_read_b128 v[76:79], v5 offset:11264
    v_exp_f32 v82, v82
    v_exp_f32 v83, v83
    v_exp_f32_e64 v84, v84
    v_smfmac_f32_16x16x64_bf16 v[148:151], v[204:207], v[104:111], v26
    v_exp_f32_e64 v85, v85
    v_mfma_f32_32x32x16_bf16 v[96:111], v[48:51], v[36:39], 0
    v_exp_f32 v86, v86
    v_exp_f32 v87, v87
    v_exp_f32_e64 v88, v88
    v_mfma_f32_32x32x16_bf16 v[96:111], v[52:55], v[40:43], v[96:111]
    ds_read_b128 v[48:51], v5 offset:16384
    ds_read_b128 v[52:55], v5 offset:17408
    v_exp_f32 v89, v89
    v_exp_f32 v90, v90
    v_exp_f32_e64 v91, v91
    v_smfmac_f32_32x32x32_bf16 v[112:127], v[64:67], v[80:87], v26
    v_exp_f32 v92, v92
    v_exp_f32 v93, v93
    v_exp_f32_e64 v94, v94
    v_smfmac_f32_16x16x64_bf16 v[144:147], v[204:207], v[80:87], v26
    v_exp_f32 v95, v95
    v_exp_f32 v96, v96
    v_exp_f32_e64 v97, v97
    v_smfmac_f32_32x32x32_bf16 v[112:127], v[68:71], v[88:95], v26
    v_exp_f32 v98, v98
    v_exp_f32 v99, v99
    v_exp_f32_e64 v100, v100
    v_smfmac_f32_16x16x64_bf16 v[144:147], v[204:207], v[88:95], v26
    v_exp_f32_e64 v101, v101
    v_mfma_f32_32x32x16_bf16 v[80:95], v[56:59], v[28:31], 0
    v_exp_f32 v102, v102
    v_exp_f32 v103, v103
    v_exp_f32_e64 v104, v104
    v_mfma_f32_32x32x16_bf16 v[80:95], v[60:63], v[32:35], v[80:95]
    v_exp_f32 v105, v105
    v_exp_f32 v106, v106
    v_exp_f32_e64 v107, v107
    v_smfmac_f32_32x32x32_bf16 v[128:143], v[64:67], v[96:103], v26
    v_exp_f32 v108, v108
    v_exp_f32 v109, v109
    v_exp_f32_e64 v110, v110
    v_smfmac_f32_16x16x64_bf16 v[148:151], v[204:207], v[96:103], v26
    v_exp_f32 v111, v111
    v_exp_f32 v80, v80
    v_exp_f32 v81, v81
    s_waitcnt lgkmcnt(0)
    v_smfmac_f32_32x32x32_bf16 v[128:143], v[68:71], v[104:111], v26
    ds_read_b128 v[64:67], v5 offset:18432
    ds_read_b128 v[68:71], v5 offset:19456
    v_exp_f32 v82, v82
    v_exp_f32 v83, v83
    v_exp_f32_e64 v84, v84
    v_smfmac_f32_16x16x64_bf16 v[148:151], v[204:207], v[104:111], v26
    v_exp_f32_e64 v85, v85
    v_mfma_f32_32x32x16_bf16 v[96:111], v[56:59], v[36:39], 0
    v_exp_f32 v86, v86
    v_exp_f32 v87, v87
    v_exp_f32_e64 v88, v88
    v_mfma_f32_32x32x16_bf16 v[96:111], v[60:63], v[40:43], v[96:111]
    ds_read_b128 v[56:59], v5 offset:24576
    ds_read_b128 v[60:63], v5 offset:25600
    v_exp_f32 v89, v89
    v_exp_f32 v90, v90
    v_exp_f32_e64 v91, v91
    v_smfmac_f32_32x32x32_bf16 v[112:127], v[72:75], v[80:87], v26
    v_exp_f32 v92, v92
    v_exp_f32 v93, v93
    v_exp_f32_e64 v94, v94
    v_smfmac_f32_16x16x64_bf16 v[144:147], v[204:207], v[80:87], v26
    s_setprio 0
    v_exp_f32 v95, v95
    v_exp_f32 v96, v96
    v_exp_f32 v97, v97
    v_smfmac_f32_32x32x32_bf16 v[112:127], v[76:79], v[88:95], v26
    v_exp_f32 v98, v98
    v_exp_f32 v99, v99
    v_exp_f32_e64 v100, v100
    v_smfmac_f32_16x16x64_bf16 v[144:147], v[204:207], v[88:95], v26
    v_exp_f32_e64 v101, v101
    v_mfma_f32_32x32x16_bf16 v[80:95], v[48:51], v[28:31], 0
    v_exp_f32 v102, v102
    v_exp_f32 v103, v103
    v_exp_f32_e64 v104, v104
    v_mfma_f32_32x32x16_bf16 v[80:95], v[52:55], v[32:35], v[80:95]
    v_exp_f32 v105, v105
    v_exp_f32 v106, v106
    v_exp_f32_e64 v107, v107
    v_smfmac_f32_32x32x32_bf16 v[128:143], v[72:75], v[96:103], v26
    s_waitcnt vmcnt(0)
    s_nop 0
    v_pk_add_f32 v[168:169], v[168:169], v[172:173]
    v_pk_add_f32 v[170:171], v[170:171], v[174:175]
    v_pk_add_f32 v[176:177], v[176:177], v[180:181]
    v_pk_add_f32 v[178:179], v[178:179], v[182:183]
    v_pk_add_f32 v[184:185], v[184:185], v[188:189]
    v_pk_add_f32 v[186:187], v[186:187], v[190:191]
    v_pk_add_f32 v[192:193], v[192:193], v[196:197]
    v_pk_add_f32 v[194:195], v[194:195], v[198:199]
    v_add_f32_dpp v200, v200, v200 quad_perm:[1,0,3,2] row_mask:0xf bank_mask:0xf
    v_add_f32_dpp v201, v201, v201 quad_perm:[1,0,3,2] row_mask:0xf bank_mask:0xf
    v_add_f32_dpp v202, v202, v202 quad_perm:[1,0,3,2] row_mask:0xf bank_mask:0xf
    v_add_f32_dpp v203, v203, v203 quad_perm:[1,0,3,2] row_mask:0xf bank_mask:0xf
    v_add_f32_dpp v200, v200, v200 quad_perm:[2,3,0,1] row_mask:0xf bank_mask:0xf
    v_add_f32_dpp v201, v201, v201 quad_perm:[2,3,0,1] row_mask:0xf bank_mask:0xf
    v_add_f32_dpp v202, v202, v202 quad_perm:[2,3,0,1] row_mask:0xf bank_mask:0xf
    v_add_f32_dpp v203, v203, v203 quad_perm:[2,3,0,1] row_mask:0xf bank_mask:0xf
    v_add_f32_dpp v200, v200, v200 row_half_mirror row_mask:0xf bank_mask:0xf
    v_add_f32_dpp v201, v201, v201 row_half_mirror row_mask:0xf bank_mask:0xf
    v_add_f32_dpp v202, v202, v202 row_half_mirror row_mask:0xf bank_mask:0xf
    v_add_f32_dpp v203, v203, v203 row_half_mirror row_mask:0xf bank_mask:0xf
    v_add_f32_dpp v200, v200, v200 row_mirror row_mask:0xf bank_mask:0xf
    v_add_f32_dpp v201, v201, v201 row_mirror row_mask:0xf bank_mask:0xf
    v_add_f32_dpp v202, v202, v202 row_mirror row_mask:0xf bank_mask:0xf
    v_add_f32_dpp v203, v203, v203 row_mirror row_mask:0xf bank_mask:0xf
    v_mov_b32 v18, v200
    v_mov_b32 v19, v201
    v_mov_b32 v20, v202
    v_mov_b32 v21, v203
    v_pk_add_f32 v[168:169], v[168:169], v[176:177]
    v_pk_add_f32 v[170:171], v[170:171], v[178:179]
    v_pk_add_f32 v[184:185], v[184:185], v[192:193]
    v_pk_add_f32 v[186:187], v[186:187], v[194:195]
    v_permlane16_swap_b32 v200, v18
    v_permlane16_swap_b32 v201, v19
    v_permlane16_swap_b32 v202, v20
    v_permlane16_swap_b32 v203, v21
    v_pk_add_f32 v[168:169], v[168:169], v[184:185]
    v_pk_add_f32 v[170:171], v[170:171], v[186:187]
    v_pk_add_f32 v[200:201], v[200:201], v[18:19]
    v_pk_add_f32 v[202:203], v[202:203], v[20:21]
    s_lshr_b32 s7, s6, 2
    s_lshl_b32 s7, s7, 11
    s_and_b32 s49, s6, 3
    s_lshl_b32 s49, s49, 4
    s_add_u32 s7, s7, s49
    s_add_u32 s7, s7, 131072
    v_lshrrev_b32 v14, 2, v8
    v_bfe_u32 v15, v1, 5, 1
    v_lshl_add_u32 v14, v15, 2, v14
    v_add_u32 v14, s7, v14
    s_lshr_b32 s7, s6, 1
    s_lshl_b32 s7, s7, 10
    s_and_b32 s49, s6, 1
    s_lshl_b32 s49, s49, 3
    s_add_u32 s7, s7, s49
    s_add_u32 s7, s7, 135168
    v_add_u32_e64 v15, s7, v2
    v_cvt_pk_bf16_f32 v168, v168, v169
    v_cvt_pk_bf16_f32 v169, v170, v171
    v_cvt_pk_bf16_f32 v200, v200, v201
    v_cvt_pk_bf16_f32 v201, v202, v203
    ds_write_b64 v14, v[168:169]
    ds_write_b64 v15, v[200:201]
    v_exp_f32 v108, v108
    v_exp_f32 v109, v109
    v_exp_f32_e64 v110, v110
    v_smfmac_f32_16x16x64_bf16 v[148:151], v[204:207], v[96:103], v26
    v_exp_f32 v111, v111
    v_exp_f32 v80, v80
    v_exp_f32 v81, v81
    s_waitcnt lgkmcnt(0)
    v_smfmac_f32_32x32x32_bf16 v[128:143], v[76:79], v[104:111], v26
    ds_read_b128 v[72:75], v5 offset:26624
    ds_read_b128 v[76:79], v5 offset:27648
    v_exp_f32 v82, v82
    v_exp_f32 v83, v83
    v_exp_f32_e64 v84, v84
    v_smfmac_f32_16x16x64_bf16 v[148:151], v[204:207], v[104:111], v26
    v_exp_f32_e64 v85, v85
    v_mfma_f32_32x32x16_bf16 v[96:111], v[48:51], v[36:39], 0
    v_exp_f32 v86, v86
    v_exp_f32 v87, v87
    v_exp_f32_e64 v88, v88
    v_mfma_f32_32x32x16_bf16 v[96:111], v[52:55], v[40:43], v[96:111]
    s_nop 0
    s_barrier
    s_setprio 1
    ds_read_b128 v[48:51], v6 offset:0
    ds_read_b128 v[52:55], v6 offset:1024
    v_exp_f32 v89, v89
    v_exp_f32 v90, v90
    v_exp_f32 v91, v91
    v_smfmac_f32_32x32x32_bf16 v[112:127], v[64:67], v[80:87], v26
    buffer_load_dwordx4 v[152:155], v2, s[16:19], s37 offen offset:0 sc1
    v_exp_f32 v92, v92
    v_exp_f32 v93, v93
    v_exp_f32_e64 v94, v94
    v_smfmac_f32_16x16x64_bf16 v[144:147], v[204:207], v[80:87], v26
    v_exp_f32 v95, v95
    v_exp_f32 v96, v96
    v_exp_f32_e64 v97, v97
    v_smfmac_f32_32x32x32_bf16 v[112:127], v[68:71], v[88:95], v26
    v_exp_f32 v98, v98
    v_exp_f32 v99, v99
    v_exp_f32_e64 v100, v100
    v_smfmac_f32_16x16x64_bf16 v[144:147], v[204:207], v[88:95], v26
    v_exp_f32_e64 v101, v101
    v_mfma_f32_32x32x16_bf16 v[80:95], v[56:59], v[28:31], 0
    v_exp_f32 v102, v102
    v_exp_f32 v103, v103
    v_exp_f32_e64 v104, v104
    v_mfma_f32_32x32x16_bf16 v[80:95], v[60:63], v[32:35], v[80:95]
    v_exp_f32 v105, v105
    v_exp_f32 v106, v106
    v_exp_f32_e64 v107, v107
    v_smfmac_f32_32x32x32_bf16 v[128:143], v[64:67], v[96:103], v26
    buffer_load_dwordx4 v[156:159], v2, s[16:19], s37 offen offset:1024 sc1
    v_exp_f32 v108, v108
    v_exp_f32 v109, v109
    v_exp_f32_e64 v110, v110
    v_smfmac_f32_16x16x64_bf16 v[148:151], v[204:207], v[96:103], v26
    v_exp_f32 v111, v111
    v_exp_f32 v80, v80
    v_exp_f32 v81, v81
    s_waitcnt lgkmcnt(0)
    v_smfmac_f32_32x32x32_bf16 v[128:143], v[68:71], v[104:111], v26
    ds_read_b128 v[64:67], v6 offset:2048
    ds_read_b128 v[68:71], v6 offset:3072
    v_exp_f32 v82, v82
    v_exp_f32 v83, v83
    v_exp_f32_e64 v84, v84
    v_smfmac_f32_16x16x64_bf16 v[148:151], v[204:207], v[104:111], v26
    v_exp_f32_e64 v85, v85
    v_mfma_f32_32x32x16_bf16 v[96:111], v[56:59], v[36:39], 0
    v_exp_f32 v86, v86
    v_exp_f32 v87, v87
    v_exp_f32_e64 v88, v88
    v_mfma_f32_32x32x16_bf16 v[96:111], v[60:63], v[40:43], v[96:111]
    ds_read_b128 v[56:59], v6 offset:8192
    ds_read_b128 v[60:63], v6 offset:9216
    v_exp_f32 v89, v89
    v_exp_f32 v90, v90
    v_exp_f32_e64 v91, v91
    v_smfmac_f32_32x32x32_bf16 v[112:127], v[72:75], v[80:87], v26
    s_add_u32 m0, s67, 32768
    s_xor_b32 s49, s66, 0
    s_lshl_b32 s49, s49, 17
    s_add_u32 s49, s49, s65
    buffer_load_dwordx4 v3, s[8:11], s49 offen lds
    buffer_load_dwordx4 v[160:163], v2, s[16:19], s38 offen offset:0 sc1
    v_exp_f32 v92, v92
    v_exp_f32 v93, v93
    v_exp_f32 v94, v94
    v_smfmac_f32_16x16x64_bf16 v[144:147], v[204:207], v[80:87], v26
    v_exp_f32 v95, v95
    v_exp_f32 v96, v96
    v_exp_f32_e64 v97, v97
    v_smfmac_f32_32x32x32_bf16 v[112:127], v[76:79], v[88:95], v26
    v_exp_f32 v98, v98
    v_exp_f32 v99, v99
    v_exp_f32_e64 v100, v100
    v_smfmac_f32_16x16x64_bf16 v[144:147], v[204:207], v[88:95], v26
    v_exp_f32_e64 v101, v101
    v_mfma_f32_32x32x16_bf16 v[80:95], v[48:51], v[28:31], 0
    v_exp_f32 v102, v102
    v_exp_f32 v103, v103
    v_exp_f32_e64 v104, v104
    v_mfma_f32_32x32x16_bf16 v[80:95], v[52:55], v[32:35], v[80:95]
    v_exp_f32 v105, v105
    v_exp_f32 v106, v106
    v_exp_f32_e64 v107, v107
    v_smfmac_f32_32x32x32_bf16 v[128:143], v[72:75], v[96:103], v26
    buffer_load_dwordx4 v4, s[8:11], s49 offen offset:1024 lds
    buffer_load_dwordx4 v[164:167], v2, s[16:19], s38 offen offset:1024 sc1
    v_exp_f32 v108, v108
    v_exp_f32 v109, v109
    v_exp_f32_e64 v110, v110
    v_smfmac_f32_16x16x64_bf16 v[148:151], v[204:207], v[96:103], v26
    v_exp_f32 v111, v111
    v_mov_b32 v5, v6
    s_add_u32 s36, s36, 32768
    s_and_b32 s36, s36, 131071
    v_add_u32_e64 v6, s36, v7
    v_bfe_u32 v14, v1, 2, 2
    v_bfe_u32 v15, v1, 5, 1
    v_lshl_add_u32 v14, v15, 2, v14
    v_bfe_u32 v15, v1, 4, 1
    v_lshl_add_u32 v14, v14, 1, v15
    v_and_b32_e64 v15, 3, v1
    v_lshl_add_u32 v14, v14, 2, v15
    v_lshlrev_b32_e64 v14, 3, v14
    v_add_u32 v14, 131072, v14
    v_add_u32 v15, 135168, v2
    v_exp_f32_e64 v80, v80
    v_exp_f32 v81, v81
    s_waitcnt lgkmcnt(0)
    v_smfmac_f32_32x32x32_bf16 v[128:143], v[76:79], v[104:111], v26
    ds_read_b128 v[72:75], v5 offset:10240
    ds_read_b128 v[76:79], v5 offset:11264
    v_exp_f32 v82, v82
    v_exp_f32 v83, v83
    v_exp_f32_e64 v84, v84
    v_smfmac_f32_16x16x64_bf16 v[148:151], v[204:207], v[104:111], v26
    v_exp_f32_e64 v85, v85
    v_mfma_f32_32x32x16_bf16 v[96:111], v[48:51], v[36:39], 0
    v_exp_f32 v86, v86
    v_exp_f32 v87, v87
    v_exp_f32_e64 v88, v88
    v_mfma_f32_32x32x16_bf16 v[96:111], v[52:55], v[40:43], v[96:111]
    ds_read_b128 v[48:51], v5 offset:16384
    ds_read_b128 v[52:55], v5 offset:17408
    v_exp_f32 v89, v89
    v_exp_f32 v90, v90
    v_exp_f32_e64 v91, v91
    v_smfmac_f32_32x32x32_bf16 v[112:127], v[64:67], v[80:87], v26
    s_add_u32 m0, s67, 49152
    s_xor_b32 s49, s66, 1
    s_lshl_b32 s49, s49, 17
    s_add_u32 s49, s49, s65
    buffer_load_dwordx4 v3, s[8:11], s49 offen lds
    v_exp_f32 v92, v92
    v_exp_f32 v93, v93
    v_exp_f32 v94, v94
    v_smfmac_f32_16x16x64_bf16 v[144:147], v[204:207], v[80:87], v26
    v_exp_f32 v95, v95
    v_exp_f32 v96, v96
    v_exp_f32_e64 v97, v97
    v_smfmac_f32_32x32x32_bf16 v[112:127], v[68:71], v[88:95], v26
    v_exp_f32 v98, v98
    v_exp_f32 v99, v99
    v_exp_f32_e64 v100, v100
    v_smfmac_f32_16x16x64_bf16 v[144:147], v[204:207], v[88:95], v26
    v_exp_f32_e64 v101, v101
    v_mfma_f32_32x32x16_bf16 v[80:95], v[56:59], v[28:31], 0
    v_exp_f32 v102, v102
    v_exp_f32 v103, v103
    v_exp_f32_e64 v104, v104
    v_mfma_f32_32x32x16_bf16 v[80:95], v[60:63], v[32:35], v[80:95]
    v_exp_f32 v105, v105
    v_exp_f32 v106, v106
    v_exp_f32_e64 v107, v107
    v_smfmac_f32_32x32x32_bf16 v[128:143], v[64:67], v[96:103], v26
    buffer_load_dwordx4 v4, s[8:11], s49 offen offset:1024 lds
    v_exp_f32 v108, v108
    v_exp_f32 v109, v109
    v_exp_f32_e64 v110, v110
    v_smfmac_f32_16x16x64_bf16 v[148:151], v[204:207], v[96:103], v26
    v_exp_f32 v111, v111
    v_exp_f32 v80, v80
    v_exp_f32 v81, v81
    s_waitcnt lgkmcnt(0)
    v_smfmac_f32_32x32x32_bf16 v[128:143], v[68:71], v[104:111], v26
    ds_read_b128 v[64:67], v5 offset:18432
    ds_read_b128 v[68:71], v5 offset:19456
    v_exp_f32 v82, v82
    v_exp_f32 v83, v83
    v_exp_f32_e64 v84, v84
    v_smfmac_f32_16x16x64_bf16 v[148:151], v[204:207], v[104:111], v26
    v_exp_f32_e64 v85, v85
    v_mfma_f32_32x32x16_bf16 v[96:111], v[56:59], v[36:39], 0
    v_exp_f32 v86, v86
    v_exp_f32 v87, v87
    v_exp_f32_e64 v88, v88
    v_mfma_f32_32x32x16_bf16 v[96:111], v[60:63], v[40:43], v[96:111]
    ds_read_b128 v[56:59], v5 offset:24576
    ds_read_b128 v[60:63], v5 offset:25600
    v_exp_f32 v89, v89
    v_exp_f32 v90, v90
    v_exp_f32_e64 v91, v91
    v_smfmac_f32_32x32x32_bf16 v[112:127], v[72:75], v[80:87], v26
    s_add_u32 m0, s67, 147456
    s_xor_b32 s49, s66, 2
    s_lshl_b32 s49, s49, 17
    s_add_u32 s49, s49, s65
    s_nop 0
    buffer_load_dwordx4 v3, s[8:11], s49 offen lds
    ds_read_b64_tr_b16 v[168:169], v14 offset:0
    ds_read_b64_tr_b16 v[170:171], v14 offset:512
    ds_read_b128 v[184:187], v15 offset:0
    v_exp_f32 v92, v92
    v_exp_f32 v93, v93
    v_exp_f32_e64 v94, v94
    v_smfmac_f32_16x16x64_bf16 v[144:147], v[204:207], v[80:87], v26
    s_setprio 0
    v_exp_f32 v95, v95
    v_exp_f32 v96, v96
    v_exp_f32 v97, v97
    v_smfmac_f32_32x32x32_bf16 v[112:127], v[76:79], v[88:95], v26
    v_exp_f32 v98, v98
    v_exp_f32 v99, v99
    v_exp_f32_e64 v100, v100
    v_smfmac_f32_16x16x64_bf16 v[144:147], v[204:207], v[88:95], v26
    v_exp_f32_e64 v101, v101
    v_mfma_f32_32x32x16_bf16 v[80:95], v[48:51], v[28:31], 0
    v_exp_f32 v102, v102
    v_exp_f32 v103, v103
    v_exp_f32_e64 v104, v104
    v_mfma_f32_32x32x16_bf16 v[80:95], v[52:55], v[32:35], v[80:95]
    v_exp_f32 v105, v105
    v_exp_f32 v106, v106
    v_exp_f32_e64 v107, v107
    v_smfmac_f32_32x32x32_bf16 v[128:143], v[72:75], v[96:103], v26
    buffer_load_dwordx4 v4, s[8:11], s49 offen offset:1024 lds
    ds_read_b64_tr_b16 v[172:173], v14 offset:1024
    ds_read_b64_tr_b16 v[174:175], v14 offset:1536
    ds_read_b128 v[188:191], v15 offset:1024
    v_exp_f32 v108, v108
    v_exp_f32 v109, v109
    v_exp_f32_e64 v110, v110
    v_smfmac_f32_16x16x64_bf16 v[148:151], v[204:207], v[96:103], v26
    v_exp_f32 v111, v111
    v_exp_f32 v80, v80
    v_exp_f32 v81, v81
    s_waitcnt lgkmcnt(0)
    v_smfmac_f32_32x32x32_bf16 v[128:143], v[76:79], v[104:111], v26
    ds_read_b128 v[72:75], v5 offset:26624
    ds_read_b128 v[76:79], v5 offset:27648
    v_exp_f32 v82, v82
    v_exp_f32 v83, v83
    v_exp_f32_e64 v84, v84
    v_smfmac_f32_16x16x64_bf16 v[148:151], v[204:207], v[104:111], v26
    v_exp_f32_e64 v85, v85
    v_mfma_f32_32x32x16_bf16 v[96:111], v[48:51], v[36:39], 0
    v_exp_f32 v86, v86
    v_exp_f32 v87, v87
    v_exp_f32_e64 v88, v88
    v_mfma_f32_32x32x16_bf16 v[96:111], v[52:55], v[40:43], v[96:111]
    s_nop 0
    s_barrier
    s_setprio 1
    v_exp_f32 v89, v89
    v_exp_f32 v90, v90
    v_exp_f32 v91, v91
    v_smfmac_f32_32x32x32_bf16 v[112:127], v[64:67], v[80:87], v26
    s_add_u32 m0, s67, 65536
    s_xor_b32 s49, s66, 3
    s_lshl_b32 s49, s49, 17
    s_add_u32 s49, s49, s65
    s_nop 0
    buffer_load_dwordx4 v3, s[8:11], s49 offen lds
    ds_read_b64_tr_b16 v[176:177], v14 offset:2048
    ds_read_b64_tr_b16 v[178:179], v14 offset:2560
    ds_read_b128 v[192:195], v15 offset:2048
    v_exp_f32 v92, v92
    v_exp_f32 v93, v93
    v_exp_f32_e64 v94, v94
    v_smfmac_f32_16x16x64_bf16 v[144:147], v[204:207], v[80:87], v26
    v_exp_f32 v95, v95
    v_exp_f32 v96, v96
    v_exp_f32_e64 v97, v97
    v_smfmac_f32_32x32x32_bf16 v[112:127], v[68:71], v[88:95], v26
    v_exp_f32 v98, v98
    v_exp_f32 v99, v99
    v_exp_f32_e64 v100, v100
    v_smfmac_f32_16x16x64_bf16 v[144:147], v[204:207], v[88:95], v26
    v_exp_f32_e64 v101, v101
    v_mfma_f32_32x32x16_bf16 v[80:95], v[56:59], v[28:31], 0
    v_exp_f32 v102, v102
    v_exp_f32 v103, v103
    v_exp_f32_e64 v104, v104
    v_mfma_f32_32x32x16_bf16 v[80:95], v[60:63], v[32:35], v[80:95]
    v_exp_f32 v105, v105
    v_exp_f32 v106, v106
    v_exp_f32_e64 v107, v107
    v_smfmac_f32_32x32x32_bf16 v[128:143], v[64:67], v[96:103], v26
    buffer_load_dwordx4 v4, s[8:11], s49 offen offset:1024 lds
    ds_read_b64_tr_b16 v[180:181], v14 offset:3072
    ds_read_b64_tr_b16 v[182:183], v14 offset:3584
    ds_read_b128 v[196:199], v15 offset:3072
    v_exp_f32 v108, v108
    v_exp_f32 v109, v109
    v_exp_f32_e64 v110, v110
    v_smfmac_f32_16x16x64_bf16 v[148:151], v[204:207], v[96:103], v26
    v_exp_f32 v111, v111
    v_exp_f32 v80, v80
    v_exp_f32 v81, v81
    s_waitcnt lgkmcnt(0)
    v_smfmac_f32_32x32x32_bf16 v[128:143], v[68:71], v[104:111], v26
    v_exp_f32 v82, v82
    v_exp_f32 v83, v83
    v_exp_f32_e64 v84, v84
    v_smfmac_f32_16x16x64_bf16 v[148:151], v[204:207], v[104:111], v26
    v_exp_f32_e64 v85, v85
    v_mfma_f32_32x32x16_bf16 v[96:111], v[56:59], v[36:39], 0
    v_exp_f32 v86, v86
    v_exp_f32 v87, v87
    v_exp_f32_e64 v88, v88
    v_mfma_f32_32x32x16_bf16 v[96:111], v[60:63], v[40:43], v[96:111]
    v_exp_f32 v89, v89
    v_exp_f32 v90, v90
    v_exp_f32_e64 v91, v91
    v_smfmac_f32_32x32x32_bf16 v[112:127], v[72:75], v[80:87], v26
    s_add_u32 m0, s67, 81920
    s_xor_b32 s49, s66, 4
    s_lshl_b32 s49, s49, 17
    s_add_u32 s49, s49, s65
    buffer_load_dwordx4 v3, s[8:11], s49 offen lds
    v_exp_f32 v92, v92
    v_exp_f32 v93, v93
    v_exp_f32 v94, v94
    v_smfmac_f32_16x16x64_bf16 v[144:147], v[204:207], v[80:87], v26
    v_exp_f32 v95, v95
    v_exp_f32 v96, v96
    v_exp_f32_e64 v97, v97
    v_smfmac_f32_32x32x32_bf16 v[112:127], v[76:79], v[88:95], v26
    v_exp_f32 v98, v98
    v_exp_f32 v99, v99
    v_exp_f32_e64 v100, v100
    v_smfmac_f32_16x16x64_bf16 v[144:147], v[204:207], v[88:95], v26
    v_exp_f32 v101, v101
    v_exp_f32 v102, v102
    v_exp_f32 v103, v103
    v_exp_f32 v104, v104
    v_exp_f32 v105, v105
    v_exp_f32 v106, v106
    v_exp_f32_e64 v107, v107
    v_smfmac_f32_32x32x32_bf16 v[128:143], v[72:75], v[96:103], v26
    buffer_load_dwordx4 v4, s[8:11], s49 offen offset:1024 lds
    v_exp_f32 v108, v108
    v_exp_f32 v109, v109
    v_exp_f32_e64 v110, v110
    v_smfmac_f32_16x16x64_bf16 v[148:151], v[204:207], v[96:103], v26
    v_exp_f32_e64 v111, v111
    s_waitcnt vmcnt(8)
    s_nop 0
    v_smfmac_f32_32x32x32_bf16 v[128:143], v[76:79], v[104:111], v26
    v_smfmac_f32_16x16x64_bf16 v[148:151], v[204:207], v[104:111], v26
    s_setprio 0
    v_mfma_f32_32x32x16_bf16 v[80:95], v[160:163], v[152:155], 0
    v_mfma_f32_32x32x16_bf16 v[80:95], v[164:167], v[156:159], v[80:95]
    v_add_u32 v5, s44, v2
    v_xor_b32 v6, 0x4000, v5
    s_lshl_b32 s7, s6, 8
    s_add_u32 s7, s7, 139264
    v_lshl_add_u32 v7, v1, 2, s7
    v_xor_b32 v8, 0x400, v7
    s_nop 3
    ds_write_b128 v5, v[128:131] offset:0
    ds_write_b128 v5, v[132:135] offset:1024
    ds_write_b128 v5, v[136:139] offset:2048
    ds_write_b128 v5, v[140:143] offset:3072
    v_mov_b32 v145, v144
    v_mov_b32 v149, v148
    s_nop 1
    v_permlane32_swap_b32 v144, v145
    v_permlane32_swap_b32_e64 v148, v149
    ds_write_b32 v7, v148
    v_mov_b32 v56, 0
    v_mov_b32 v60, 0
    v_pk_mul_f32 v[80:81], v[80:81], s[24:25]
    v_pk_mul_f32 v[82:83], v[82:83], s[24:25]
    v_pk_mul_f32 v[84:85], v[84:85], s[24:25]
    v_pk_mul_f32 v[86:87], v[86:87], s[24:25]
    v_pk_mul_f32 v[88:89], v[88:89], s[24:25]
    v_pk_mul_f32 v[90:91], v[90:91], s[24:25]
    v_pk_mul_f32 v[92:93], v[92:93], s[24:25]
    v_pk_mul_f32 v[94:95], v[94:95], s[24:25]
    v_exp_f32 v96, -v80
    v_exp_f32_e64 v80, v80
    v_exp_f32 v97, -v81
    v_exp_f32_e64 v81, v81
    v_exp_f32 v98, -v82
    v_exp_f32_e64 v82, v82
    v_exp_f32 v99, -v83
    v_exp_f32_e64 v83, v83
    v_exp_f32 v100, -v84
    v_exp_f32_e64 v84, v84
    v_exp_f32 v101, -v85
    v_exp_f32_e64 v85, v85
    v_exp_f32 v102, -v86
    v_exp_f32_e64 v86, v86
    v_exp_f32 v103, -v87
    v_exp_f32_e64 v87, v87
    v_exp_f32 v104, -v88
    v_exp_f32_e64 v88, v88
    v_exp_f32 v105, -v89
    v_exp_f32_e64 v89, v89
    v_smfmac_f32_16x16x64_bf16 v[60:63], v[44:47], v[96:103], v26
    v_smfmac_f32_16x16x64_bf16 v[56:59], v[44:47], v[80:87], v26
    v_exp_f32 v106, -v90
    v_exp_f32_e64 v90, v90
    v_exp_f32 v107, -v91
    v_exp_f32_e64 v91, v91
    v_exp_f32 v108, -v92
    v_exp_f32_e64 v92, v92
    v_exp_f32 v109, -v93
    v_exp_f32_e64 v93, v93
    v_exp_f32 v110, -v94
    v_exp_f32_e64 v94, v94
    v_exp_f32 v111, -v95
    v_exp_f32 v95, v95
    s_nop 1
    v_smfmac_f32_16x16x64_bf16 v[60:63], v[44:47], v[104:111], v26
    v_smfmac_f32_16x16x64_bf16 v[56:59], v[44:47], v[88:95], v26
    s_mov_b32 s58, 0x2b800000
    s_mov_b32 s59, 0x71800000
    s_nop 5
    v_cmp_nge_f32 vcc, s26, v56
    v_cmp_nge_f32 s[28:29], s26, v60
    v_rcp_f32 v56, v56
    v_rcp_f32 v60, v60
    s_or_b64 vcc, vcc, s[28:29]
    s_cbranch_scc1 FSLOW_88
    v_pk_mul_f32 v[80:81], v[80:81], v[56:57] op_sel_hi:[1,0]
    v_pk_mul_f32 v[96:97], v[96:97], v[60:61] op_sel_hi:[1,0]
    v_pk_mul_f32 v[82:83], v[82:83], v[56:57] op_sel_hi:[1,0]
    v_pk_mul_f32 v[98:99], v[98:99], v[60:61] op_sel_hi:[1,0]
    v_pk_mul_f32 v[84:85], v[84:85], v[56:57] op_sel_hi:[1,0]
    v_pk_mul_f32 v[100:101], v[100:101], v[60:61] op_sel_hi:[1,0]
    v_pk_mul_f32 v[86:87], v[86:87], v[56:57] op_sel_hi:[1,0]
    v_pk_mul_f32 v[102:103], v[102:103], v[60:61] op_sel_hi:[1,0]
    v_pk_mul_f32 v[88:89], v[88:89], v[56:57] op_sel_hi:[1,0]
    v_pk_mul_f32 v[104:105], v[104:105], v[60:61] op_sel_hi:[1,0]
    v_pk_mul_f32 v[90:91], v[90:91], v[56:57] op_sel_hi:[1,0]
    v_pk_mul_f32 v[106:107], v[106:107], v[60:61] op_sel_hi:[1,0]
    v_pk_mul_f32 v[92:93], v[92:93], v[56:57] op_sel_hi:[1,0]
    v_pk_mul_f32 v[108:109], v[108:109], v[60:61] op_sel_hi:[1,0]
    v_pk_mul_f32 v[94:95], v[94:95], v[56:57] op_sel_hi:[1,0]
    v_pk_mul_f32 v[110:111], v[110:111], v[60:61] op_sel_hi:[1,0]
    v_cvt_pk_bf16_f32 v36, v80, v81
    v_cvt_pk_bf16_f32 v72, v96, v97
    v_cvt_pk_bf16_f32 v37, v82, v83
    v_cvt_pk_bf16_f32 v73, v98, v99
    v_cvt_pk_bf16_f32 v38, v84, v85
    v_cvt_pk_bf16_f32 v74, v100, v101
    v_cvt_pk_bf16_f32 v39, v86, v87
    v_cvt_pk_bf16_f32 v75, v102, v103
    v_cvt_pk_bf16_f32 v40, v88, v89
    v_cvt_pk_bf16_f32 v76, v104, v105
    v_cvt_pk_bf16_f32 v41, v90, v91
    v_cvt_pk_bf16_f32 v77, v106, v107
    v_cvt_pk_bf16_f32 v42, v92, v93
    v_cvt_pk_bf16_f32 v78, v108, v109
    v_cvt_pk_bf16_f32 v43, v94, v95
    v_cvt_pk_bf16_f32 v79, v110, v111
FBACK_89:
    s_nop 1
    s_nop 0
    v_mfma_f32_32x32x16_bf16 v[96:111], v[184:187], v[36:39], 0
    v_mfma_f32_32x32x16_bf16 v[96:111], v[188:191], v[40:43], v[96:111]
    v_mfma_f32_32x32x16_bf16 v[96:111], v[192:195], v[72:75], v[96:111]
    v_mfma_f32_32x32x16_bf16 v[96:111], v[196:199], v[76:79], v[96:111]
    v_mfma_f32_32x32x16_bf16 v[80:95], v[168:171], v[36:39], 0
    v_mfma_f32_32x32x16_bf16 v[80:95], v[172:175], v[40:43], v[80:95]
    v_mfma_f32_32x32x16_bf16 v[80:95], v[176:179], v[72:75], v[80:95]
    v_mfma_f32_32x32x16_bf16 v[80:95], v[180:183], v[76:79], v[80:95]
    s_nop 7
    v_add_f32 v14, 0x358637bd, v96
    v_rcp_f32 v14, v14
    s_nop 2
    s_nop 0
    v_pk_mul_f32 v[80:81], v[80:81], v[14:15] op_sel_hi:[1,0]
    v_pk_mul_f32 v[82:83], v[82:83], v[14:15] op_sel_hi:[1,0]
    v_pk_mul_f32 v[84:85], v[84:85], v[14:15] op_sel_hi:[1,0]
    v_pk_mul_f32 v[86:87], v[86:87], v[14:15] op_sel_hi:[1,0]
    v_pk_mul_f32 v[88:89], v[88:89], v[14:15] op_sel_hi:[1,0]
    v_pk_mul_f32 v[90:91], v[90:91], v[14:15] op_sel_hi:[1,0]
    v_pk_mul_f32 v[92:93], v[92:93], v[14:15] op_sel_hi:[1,0]
    v_pk_mul_f32 v[94:95], v[94:95], v[14:15] op_sel_hi:[1,0]
    v_cvt_pk_bf16_f32 v152, v80, v81
    v_cvt_pk_bf16_f32 v153, v82, v83
    v_cvt_pk_bf16_f32 v154, v84, v85
    v_cvt_pk_bf16_f32 v155, v86, v87
    v_cvt_pk_bf16_f32 v156, v88, v89
    v_cvt_pk_bf16_f32 v157, v90, v91
    v_cvt_pk_bf16_f32 v158, v92, v93
    v_cvt_pk_bf16_f32 v159, v94, v95
    buffer_store_dwordx4 v[152:155], v2, s[16:19], s62 offen offset:0 sc1
    buffer_store_dwordx4 v[156:159], v2, s[16:19], s62 offen offset:1024 sc1
    s_waitcnt lgkmcnt(0)
    s_barrier
    ds_read_b32 v148, v8
    ds_read_b128 v[128:131], v6 offset:0
    ds_read_b128 v[132:135], v6 offset:1024
    ds_read_b128 v[136:139], v6 offset:2048
    ds_read_b128 v[140:143], v6 offset:3072
    s_waitcnt lgkmcnt(4)
    v_add_f32 v144, v144, v148
    v_rcp_f32 v16, v144
    v_cmp_nle_f32 vcc, s58, v144
    v_cmp_nge_f32 s[28:29], s59, v144
    s_or_b64 vcc, vcc, s[28:29]
    s_waitcnt lgkmcnt(3)
    v_pk_add_f32 v[112:113], v[112:113], v[128:129]
    v_pk_add_f32 v[114:115], v[114:115], v[130:131]
    s_waitcnt lgkmcnt(2)
    v_pk_add_f32 v[116:117], v[116:117], v[132:133]
    v_pk_add_f32 v[118:119], v[118:119], v[134:135]
    s_waitcnt lgkmcnt(1)
    v_pk_add_f32 v[120:121], v[120:121], v[136:137]
    v_pk_add_f32 v[122:123], v[122:123], v[138:139]
    s_waitcnt lgkmcnt(0)
    s_nop 0
    v_pk_add_f32 v[124:125], v[124:125], v[140:141]
    v_pk_add_f32 v[126:127], v[126:127], v[142:143]
    v_pk_mul_f32 v[18:19], v[112:113], 0
    v_pk_mul_f32 v[20:21], v[114:115], 0
    v_pk_fma_f32 v[18:19], v[116:117], 0, v[18:19]
    v_pk_fma_f32 v[20:21], v[118:119], 0, v[20:21]
    v_pk_fma_f32 v[18:19], v[120:121], 0, v[18:19]
    v_pk_fma_f32 v[20:21], v[122:123], 0, v[20:21]
    v_pk_fma_f32 v[18:19], v[124:125], 0, v[18:19]
    v_pk_fma_f32 v[20:21], v[126:127], 0, v[20:21]
    v_pk_add_f32 v[18:19], v[18:19], v[20:21]
    v_cmp_u_f32 s[28:29], v18, v19
    s_or_b64 vcc, vcc, s[28:29]
    s_cbranch_scc1 ATSLOW_90
ATFIN_91:
    v_pk_mul_f32 v[112:113], v[112:113], v[16:17] op_sel_hi:[1,0]
    v_pk_mul_f32 v[114:115], v[114:115], v[16:17] op_sel_hi:[1,0]
    v_pk_mul_f32 v[116:117], v[116:117], v[16:17] op_sel_hi:[1,0]
    v_pk_mul_f32 v[118:119], v[118:119], v[16:17] op_sel_hi:[1,0]
    v_pk_mul_f32 v[120:121], v[120:121], v[16:17] op_sel_hi:[1,0]
    v_pk_mul_f32 v[122:123], v[122:123], v[16:17] op_sel_hi:[1,0]
    v_pk_mul_f32 v[124:125], v[124:125], v[16:17] op_sel_hi:[1,0]
    v_pk_mul_f32 v[126:127], v[126:127], v[16:17] op_sel_hi:[1,0]
    v_cvt_pk_bf16_f32 v48, v112, v113
    v_cvt_pk_bf16_f32 v49, v114, v115
    v_cvt_pk_bf16_f32 v50, v116, v117
    v_cvt_pk_bf16_f32 v51, v118, v119
    v_cvt_pk_bf16_f32 v52, v120, v121
    v_cvt_pk_bf16_f32 v53, v122, v123
    v_cvt_pk_bf16_f32 v54, v124, v125
    v_cvt_pk_bf16_f32 v55, v126, v127
    buffer_store_dwordx4 v[48:51], v2, s[16:19], s63 offen offset:0 sc1
    buffer_store_dwordx4 v[52:55], v2, s[16:19], s63 offen offset:1024 sc1
    s_mov_b64 exec, -1
    s_lshl_b32 s50, s33, 7
    s_lshl_b32 s7, s32, 2
    s_add_u32 s50, s50, s7
    s_add_u32 s50, s50, 20451328
    s_bfe_u32 s3, s2, 0x10002
    v_lshrrev_b32 v14, 4, v1
    v_and_b32 v15, 15, v1
    v_lshlrev_b32_e64 v5, 9, v14
    v_lshl_add_u32 v5, v15, 4, v5
    s_lshl_b32 s40, s3, 22
    s_lshl_b32 s7, s68, 18
    s_add_u32 s40, s40, s7
    s_and_b32 s7, s6, 3
    s_lshl_b32 s7, s7, 16
    s_add_u32 s40, s40, s7
    s_lshl_b32 s7, s45, 11
    s_add_u32 s40, s40, s7
    s_add_u32 s40, s40, 20971520
    v_bfe_u32 v16, v1, 2, 3
    v_bfe_u32 v17, v1, 5, 1
    v_lshl_add_u32 v17, v17, 4, v16
    v_lshlrev_b32 v17, 8, v17
    v_and_b32 v18, 1, v1
    v_lshl_add_u32 v17, v18, 3, v17
    s_lshl_b32 s7, s45, 13
    v_add_u32 v17, s7, v17
    v_lshlrev_b32_e64 v16, 1, v16
    v_bfe_u32 v18, v1, 1, 1
    v_or_b32 v16, v16, v18
    s_lshl_b32 s7, s45, 3
    v_xor_b32 v16, s7, v16
    v_xor_b32 v18, 0, v16
    v_lshl_add_u32 v6, v18, 4, v17
    v_xor_b32_e64 v18, 2, v16
    v_lshl_add_u32 v7, v18, 4, v17
    v_xor_b32_e64 v18, 4, v16
    v_lshl_add_u32 v8, v18, 4, v17
    v_xor_b32_e64 v18, 6, v16
    v_lshl_add_u32 v9, v18, 4, v17
    v_xor_b32_e64 v18, 8, v16
    v_lshl_add_u32 v10, v18, 4, v17
    v_xor_b32_e64 v18, 10, v16
    v_lshl_add_u32 v11, v18, 4, v17
    v_xor_b32_e64 v18, 12, v16
    v_lshl_add_u32 v12, v18, 4, v17
    v_xor_b32_e64 v18, 14, v16
    v_lshl_add_u32 v13, v18, 4, v17
    s_lshr_b32 s51, s68, 1
    s_lshl_b32 s51, s51, 7
    s_add_u32 s51, s51, 20451328
    s_waitcnt vmcnt(0)
    s_barrier
    s_cmp_lg_u32 s6, 0
    s_cbranch_scc1 NF_101
    v_mov_b32_e64 v14, 0
    v_mov_b32 v15, 1
    s_mov_b64 exec, 1
    buffer_store_dword v15, v14, s[16:19], s50 offen sc1
    s_mov_b64 exec, -1
NF_101:
    s_add_u32 m0, s67, 98304
    s_xor_b32 s49, s66, 5
    s_lshl_b32 s49, s49, 17
    s_add_u32 s49, s49, s65
    buffer_load_dwordx4 v3, s[8:11], s49 offen lds
    buffer_load_dwordx4 v4, s[8:11], s49 offen offset:1024 lds
    s_add_u32 m0, s67, 114688
    s_xor_b32 s49, s66, 6
    s_lshl_b32 s49, s49, 17
    s_add_u32 s49, s49, s65
    buffer_load_dwordx4 v3, s[8:11], s49 offen lds
    buffer_load_dwordx4 v4, s[8:11], s49 offen offset:1024 lds
    s_add_u32 m0, s67, 131072
    s_xor_b32 s49, s66, 7
    s_lshl_b32 s49, s49, 17
    s_add_u32 s49, s49, s65
    buffer_load_dwordx4 v3, s[8:11], s49 offen lds
    buffer_load_dwordx4 v4, s[8:11], s49 offen offset:1024 lds
    s_add_u32 m0, s67, 0
    s_xor_b32 s49, s66, 8
    s_lshl_b32 s49, s49, 17
    s_add_u32 s49, s49, s65
    buffer_load_dwordx4 v3, s[8:11], s49 offen lds
    buffer_load_dwordx4 v4, s[8:11], s49 offen offset:1024 lds
    s_add_u32 m0, s67, 16384
    s_xor_b32 s49, s66, 9
    s_lshl_b32 s49, s49, 17
    s_add_u32 s49, s49, s65
    s_nop 0
    buffer_load_dwordx4 v3, s[8:11], s49 offen lds
    buffer_load_dwordx4 v4, s[8:11], s49 offen offset:1024 lds
    v_add_u32 v20, 65536, v6
    v_add_u32 v21, 65536, v7
    v_add_u32 v22, 65536, v8
    v_add_u32 v23, 65536, v9
    v_add_u32 v24, 65536, v10
    v_add_u32 v25, 65536, v11
    v_add_u32 v26, 65536, v12
    v_add_u32 v27, 65536, v13
    v_add_u32 v28, 131072, v6
    v_add_u32 v29, 131072, v7
    v_add_u32 v30, 131072, v8
    v_add_u32 v31, 131072, v9
    v_add_u32 v32, 131072, v10
    v_add_u32 v33, 131072, v11
    v_add_u32 v34, 131072, v12
    v_add_u32 v35, 131072, v13
    ds_read_b64_tr_b16 v[64:65], v6 offset:32768
    ds_read_b64_tr_b16 v[66:67], v6 offset:34816
    ds_read_b64_tr_b16 v[68:69], v7 offset:32768
    ds_read_b64_tr_b16 v[70:71], v7 offset:34816
    ds_read_b64_tr_b16 v[72:73], v8 offset:32768
    ds_read_b64_tr_b16 v[74:75], v8 offset:34816
    ds_read_b64_tr_b16 v[76:77], v9 offset:32768
    ds_read_b64_tr_b16 v[78:79], v9 offset:34816
    ds_read_b64_tr_b16 v[80:81], v10 offset:32768
    ds_read_b64_tr_b16 v[82:83], v10 offset:34816
    ds_read_b64_tr_b16 v[84:85], v11 offset:32768
    ds_read_b64_tr_b16 v[86:87], v11 offset:34816
    ds_read_b64_tr_b16 v[88:89], v12 offset:32768
    ds_read_b64_tr_b16 v[90:91], v12 offset:34816
    ds_read_b64_tr_b16 v[92:93], v13 offset:32768
    ds_read_b64_tr_b16 v[94:95], v13 offset:34816
    s_lshl_b32 s7, s6, 13
    v_add_u32 v36, s7, v2
    v_xor_b32 v37, 0x8000, v36
    v_and_b32 v38, 15, v1
    v_lshlrev_b32 v38, 12, v38
    v_bfe_u32 v16, v1, 4, 1
    v_lshl_add_u32 v38, v16, 5, v38
    v_bfe_u32 v16, v1, 5, 1
    v_lshl_add_u32 v38, v16, 4, v38
    s_lshl_b32 s54, s68, 19
    s_and_b32 s7, s6, 3
    s_lshl_b32 s7, s7, 17
    s_add_u32 s54, s54, s7
    s_lshl_b32 s7, s3, 11
    s_add_u32 s54, s54, s7
    s_lshl_b32 s7, s69, 8
    s_add_u32 s54, s54, s7
    s_lshl_b32 s7, s45, 7
    s_add_u32 s54, s54, s7
    s_add_u32 s55, s54, 65536
    s_cmp_lg_u32 s6, 0
    s_cbranch_scc1 GO_102
    v_and_b32 v18, 31, v1
    v_lshlrev_b32 v18, 2, v18
    s_mov_b32 s27, 0x40000
PL_103:
    buffer_load_dword v19, v18, s[16:19], s51 offen sc1
    s_sub_u32 s27, s27, 1
    s_cbranch_scc1 GO_102
    s_waitcnt vmcnt(0)
    v_cmp_ne_u32 vcc, 1, v19
    s_nop 4
    s_cbranch_vccz GO_102
    s_sleep 1
    s_branch PL_103
GO_102:
    s_barrier
    s_xor_b32 s42, s66, 0
    s_lshl_b32 s42, s42, 12
    s_add_u32 s42, s42, s40
    buffer_load_dwordx4 v[192:195], v5, s[16:19], s42 offen sc1
    buffer_load_dwordx4 v[196:199], v5, s[16:19], s42 offen offset:256 sc1
    s_barrier
    s_xor_b32 s42, s66, 1
    s_lshl_b32 s42, s42, 12
    s_add_u32 s42, s42, s40
    buffer_load_dwordx4 v[200:203], v5, s[16:19], s42 offen sc1
    buffer_load_dwordx4 v[204:207], v5, s[16:19], s42 offen offset:256 sc1
    s_xor_b32 s42, s66, 2
    s_lshl_b32 s42, s42, 12
    s_add_u32 s42, s42, s40
    buffer_load_dwordx4 v[208:211], v5, s[16:19], s42 offen sc1
    buffer_load_dwordx4 v[212:215], v5, s[16:19], s42 offen offset:256 sc1
    s_xor_b32 s42, s66, 3
    s_lshl_b32 s42, s42, 12
    s_add_u32 s42, s42, s40
    buffer_load_dwordx4 v[216:219], v5, s[16:19], s42 offen sc1
    buffer_load_dwordx4 v[220:223], v5, s[16:19], s42 offen offset:256 sc1
    s_cmp_ge_u32 s6, 4
    s_cbranch_scc1 G3HI_104
    s_branch G3LO_106
.p2align 12
G3LO_106:
    s_waitcnt vmcnt(6) lgkmcnt(0)
    s_nop 0
    v_mfma_f32_16x16x32_bf16 v[128:131], v[64:67], v[192:195], 0
    ds_read_b64_tr_b16 v[96:97], v6 offset:49152
    v_mfma_f32_16x16x32_bf16 v[132:135], v[68:71], v[192:195], 0
    ds_read_b64_tr_b16 v[98:99], v6 offset:51200
    v_mfma_f32_16x16x32_bf16 v[136:139], v[72:75], v[192:195], 0
    ds_read_b64_tr_b16 v[100:101], v7 offset:49152
    v_mfma_f32_16x16x32_bf16 v[140:143], v[76:79], v[192:195], 0
    ds_read_b64_tr_b16 v[102:103], v7 offset:51200
    v_mfma_f32_16x16x32_bf16 v[160:163], v[80:83], v[192:195], 0
    ds_read_b64_tr_b16 v[104:105], v8 offset:49152
    v_mfma_f32_16x16x32_bf16 v[164:167], v[84:87], v[192:195], 0
    ds_read_b64_tr_b16 v[106:107], v8 offset:51200
    v_mfma_f32_16x16x32_bf16 v[168:171], v[88:91], v[192:195], 0
    ds_read_b64_tr_b16 v[108:109], v9 offset:49152
    v_mfma_f32_16x16x32_bf16 v[172:175], v[92:95], v[192:195], 0
    ds_read_b64_tr_b16 v[110:111], v9 offset:51200
    v_mfma_f32_16x16x32_bf16 v[188:191], v[92:95], v[196:199], 0
    ds_read_b64_tr_b16 v[112:113], v10 offset:49152
    v_mfma_f32_16x16x32_bf16 v[184:187], v[88:91], v[196:199], 0
    ds_read_b64_tr_b16 v[114:115], v10 offset:51200
    v_mfma_f32_16x16x32_bf16 v[180:183], v[84:87], v[196:199], 0
    ds_read_b64_tr_b16 v[116:117], v11 offset:49152
    v_mfma_f32_16x16x32_bf16 v[176:179], v[80:83], v[196:199], 0
    ds_read_b64_tr_b16 v[118:119], v11 offset:51200
    v_mfma_f32_16x16x32_bf16 v[156:159], v[76:79], v[196:199], 0
    ds_read_b64_tr_b16 v[120:121], v12 offset:49152
    v_mfma_f32_16x16x32_bf16 v[152:155], v[72:75], v[196:199], 0
    ds_read_b64_tr_b16 v[122:123], v12 offset:51200
    v_mfma_f32_16x16x32_bf16 v[148:151], v[68:71], v[196:199], 0
    ds_read_b64_tr_b16 v[124:125], v13 offset:49152
    v_mfma_f32_16x16x32_bf16 v[144:147], v[64:67], v[196:199], 0
    ds_read_b64_tr_b16 v[126:127], v13 offset:51200
    s_waitcnt vmcnt(4) lgkmcnt(8)
    s_nop 0
    v_mfma_f32_16x16x32_bf16 v[128:131], v[96:99], v[200:203], v[128:131]
    ds_read_b64_tr_b16 v[64:65], v28 offset:16384
    v_mfma_f32_16x16x32_bf16 v[132:135], v[100:103], v[200:203], v[132:135]
    ds_read_b64_tr_b16 v[66:67], v28 offset:18432
    v_mfma_f32_16x16x32_bf16 v[136:139], v[104:107], v[200:203], v[136:139]
    ds_read_b64_tr_b16 v[68:69], v29 offset:16384
    v_mfma_f32_16x16x32_bf16 v[140:143], v[108:111], v[200:203], v[140:143]
    ds_read_b64_tr_b16 v[70:71], v29 offset:18432
    s_waitcnt lgkmcnt(4)
    s_nop 0
    v_mfma_f32_16x16x32_bf16 v[160:163], v[112:115], v[200:203], v[160:163]
    ds_read_b64_tr_b16 v[72:73], v30 offset:16384
    v_mfma_f32_16x16x32_bf16 v[164:167], v[116:119], v[200:203], v[164:167]
    ds_read_b64_tr_b16 v[74:75], v30 offset:18432
    v_mfma_f32_16x16x32_bf16 v[168:171], v[120:123], v[200:203], v[168:171]
    ds_read_b64_tr_b16 v[76:77], v31 offset:16384
    v_mfma_f32_16x16x32_bf16 v[172:175], v[124:127], v[200:203], v[172:175]
    ds_read_b64_tr_b16 v[78:79], v31 offset:18432
    v_mfma_f32_16x16x32_bf16 v[188:191], v[124:127], v[204:207], v[188:191]
    ds_read_b64_tr_b16 v[80:81], v32 offset:16384
    v_mfma_f32_16x16x32_bf16 v[184:187], v[120:123], v[204:207], v[184:187]
    ds_read_b64_tr_b16 v[82:83], v32 offset:18432
    v_mfma_f32_16x16x32_bf16 v[180:183], v[116:119], v[204:207], v[180:183]
    ds_read_b64_tr_b16 v[84:85], v33 offset:16384
    v_mfma_f32_16x16x32_bf16 v[176:179], v[112:115], v[204:207], v[176:179]
    ds_read_b64_tr_b16 v[86:87], v33 offset:18432
    v_mfma_f32_16x16x32_bf16 v[156:159], v[108:111], v[204:207], v[156:159]
    ds_read_b64_tr_b16 v[88:89], v34 offset:16384
    v_mfma_f32_16x16x32_bf16 v[152:155], v[104:107], v[204:207], v[152:155]
    ds_read_b64_tr_b16 v[90:91], v34 offset:18432
    v_mfma_f32_16x16x32_bf16 v[148:151], v[100:103], v[204:207], v[148:151]
    ds_read_b64_tr_b16 v[92:93], v35 offset:16384
    v_mfma_f32_16x16x32_bf16 v[144:147], v[96:99], v[204:207], v[144:147]
    ds_read_b64_tr_b16 v[94:95], v35 offset:18432
    s_xor_b32 s42, s66, 4
    s_lshl_b32 s42, s42, 12
    s_add_u32 s42, s42, s40
    buffer_load_dwordx4 v[224:227], v5, s[16:19], s42 offen sc1
    buffer_load_dwordx4 v[228:231], v5, s[16:19], s42 offen offset:256 sc1
    s_xor_b32 s42, s66, 5
    s_lshl_b32 s42, s42, 12
    s_add_u32 s42, s42, s40
    buffer_load_dwordx4 v[232:235], v5, s[16:19], s42 offen sc1
    buffer_load_dwordx4 v[236:239], v5, s[16:19], s42 offen offset:256 sc1
    s_waitcnt vmcnt(6) lgkmcnt(8)
    s_barrier
    v_mfma_f32_16x16x32_bf16 v[128:131], v[64:67], v[208:211], v[128:131]
    ds_read_b64_tr_b16 v[96:97], v20 offset:0
    v_mfma_f32_16x16x32_bf16 v[132:135], v[68:71], v[208:211], v[132:135]
    ds_read_b64_tr_b16 v[98:99], v20 offset:2048
    v_mfma_f32_16x16x32_bf16 v[136:139], v[72:75], v[208:211], v[136:139]
    ds_read_b64_tr_b16 v[100:101], v21 offset:0
    v_mfma_f32_16x16x32_bf16 v[140:143], v[76:79], v[208:211], v[140:143]
    ds_read_b64_tr_b16 v[102:103], v21 offset:2048
    s_waitcnt lgkmcnt(4)
    s_nop 0
    v_mfma_f32_16x16x32_bf16 v[160:163], v[80:83], v[208:211], v[160:163]
    ds_read_b64_tr_b16 v[104:105], v22 offset:0
    v_mfma_f32_16x16x32_bf16 v[164:167], v[84:87], v[208:211], v[164:167]
    ds_read_b64_tr_b16 v[106:107], v22 offset:2048
    v_mfma_f32_16x16x32_bf16 v[168:171], v[88:91], v[208:211], v[168:171]
    ds_read_b64_tr_b16 v[108:109], v23 offset:0
    v_mfma_f32_16x16x32_bf16 v[172:175], v[92:95], v[208:211], v[172:175]
    ds_read_b64_tr_b16 v[110:111], v23 offset:2048
    v_mfma_f32_16x16x32_bf16 v[188:191], v[92:95], v[212:215], v[188:191]
    ds_read_b64_tr_b16 v[112:113], v24 offset:0
    v_mfma_f32_16x16x32_bf16 v[184:187], v[88:91], v[212:215], v[184:187]
    ds_read_b64_tr_b16 v[114:115], v24 offset:2048
    v_mfma_f32_16x16x32_bf16 v[180:183], v[84:87], v[212:215], v[180:183]
    ds_read_b64_tr_b16 v[116:117], v25 offset:0
    v_mfma_f32_16x16x32_bf16 v[176:179], v[80:83], v[212:215], v[176:179]
    ds_read_b64_tr_b16 v[118:119], v25 offset:2048
    v_mfma_f32_16x16x32_bf16 v[156:159], v[76:79], v[212:215], v[156:159]
    ds_read_b64_tr_b16 v[120:121], v26 offset:0
    v_mfma_f32_16x16x32_bf16 v[152:155], v[72:75], v[212:215], v[152:155]
    ds_read_b64_tr_b16 v[122:123], v26 offset:2048
    v_mfma_f32_16x16x32_bf16 v[148:151], v[68:71], v[212:215], v[148:151]
    ds_read_b64_tr_b16 v[124:125], v27 offset:0
    v_mfma_f32_16x16x32_bf16 v[144:147], v[64:67], v[212:215], v[144:147]
    ds_read_b64_tr_b16 v[126:127], v27 offset:2048
    s_waitcnt vmcnt(4) lgkmcnt(8)
    s_nop 0
    v_mfma_f32_16x16x32_bf16 v[128:131], v[96:99], v[216:219], v[128:131]
    ds_read_b64_tr_b16 v[64:65], v20 offset:16384
    v_mfma_f32_16x16x32_bf16 v[132:135], v[100:103], v[216:219], v[132:135]
    ds_read_b64_tr_b16 v[66:67], v20 offset:18432
    v_mfma_f32_16x16x32_bf16 v[136:139], v[104:107], v[216:219], v[136:139]
    ds_read_b64_tr_b16 v[68:69], v21 offset:16384
    v_mfma_f32_16x16x32_bf16 v[140:143], v[108:111], v[216:219], v[140:143]
    ds_read_b64_tr_b16 v[70:71], v21 offset:18432
    s_waitcnt lgkmcnt(4)
    s_nop 0
    v_mfma_f32_16x16x32_bf16 v[160:163], v[112:115], v[216:219], v[160:163]
    ds_read_b64_tr_b16 v[72:73], v22 offset:16384
    v_mfma_f32_16x16x32_bf16 v[164:167], v[116:119], v[216:219], v[164:167]
    ds_read_b64_tr_b16 v[74:75], v22 offset:18432
    v_mfma_f32_16x16x32_bf16 v[168:171], v[120:123], v[216:219], v[168:171]
    ds_read_b64_tr_b16 v[76:77], v23 offset:16384
    v_mfma_f32_16x16x32_bf16 v[172:175], v[124:127], v[216:219], v[172:175]
    ds_read_b64_tr_b16 v[78:79], v23 offset:18432
    v_mfma_f32_16x16x32_bf16 v[188:191], v[124:127], v[220:223], v[188:191]
    ds_read_b64_tr_b16 v[80:81], v24 offset:16384
    v_mfma_f32_16x16x32_bf16 v[184:187], v[120:123], v[220:223], v[184:187]
    ds_read_b64_tr_b16 v[82:83], v24 offset:18432
    v_mfma_f32_16x16x32_bf16 v[180:183], v[116:119], v[220:223], v[180:183]
    ds_read_b64_tr_b16 v[84:85], v25 offset:16384
    v_mfma_f32_16x16x32_bf16 v[176:179], v[112:115], v[220:223], v[176:179]
    ds_read_b64_tr_b16 v[86:87], v25 offset:18432
    v_mfma_f32_16x16x32_bf16 v[156:159], v[108:111], v[220:223], v[156:159]
    ds_read_b64_tr_b16 v[88:89], v26 offset:16384
    v_mfma_f32_16x16x32_bf16 v[152:155], v[104:107], v[220:223], v[152:155]
    ds_read_b64_tr_b16 v[90:91], v26 offset:18432
    v_mfma_f32_16x16x32_bf16 v[148:151], v[100:103], v[220:223], v[148:151]
    ds_read_b64_tr_b16 v[92:93], v27 offset:16384
    v_mfma_f32_16x16x32_bf16 v[144:147], v[96:99], v[220:223], v[144:147]
    ds_read_b64_tr_b16 v[94:95], v27 offset:18432
    s_xor_b32 s42, s66, 6
    s_lshl_b32 s42, s42, 12
    s_add_u32 s42, s42, s40
    buffer_load_dwordx4 v[240:243], v5, s[16:19], s42 offen sc1
    buffer_load_dwordx4 v[244:247], v5, s[16:19], s42 offen offset:256 sc1
    s_xor_b32 s42, s66, 7
    s_lshl_b32 s42, s42, 12
    s_add_u32 s42, s42, s40
    buffer_load_dwordx4 v[248:251], v5, s[16:19], s42 offen sc1
    buffer_load_dwordx4 v[252:255], v5, s[16:19], s42 offen offset:256 sc1
    s_add_u32 m0, s67, 32768
    s_xor_b32 s49, s66, 10
    s_lshl_b32 s49, s49, 17
    s_add_u32 s49, s49, s65
    buffer_load_dwordx4 v3, s[8:11], s49 offen lds
    buffer_load_dwordx4 v4, s[8:11], s49 offen offset:1024 lds
    s_add_u32 m0, s67, 49152
    s_xor_b32 s49, s66, 11
    s_lshl_b32 s49, s49, 17
    s_add_u32 s49, s49, s65
    buffer_load_dwordx4 v3, s[8:11], s49 offen lds
    buffer_load_dwordx4 v4, s[8:11], s49 offen offset:1024 lds
    s_waitcnt vmcnt(10) lgkmcnt(8)
    s_barrier
    v_mfma_f32_16x16x32_bf16 v[128:131], v[64:67], v[224:227], v[128:131]
    ds_read_b64_tr_b16 v[96:97], v20 offset:32768
    v_mfma_f32_16x16x32_bf16 v[132:135], v[68:71], v[224:227], v[132:135]
    ds_read_b64_tr_b16 v[98:99], v20 offset:34816
    v_mfma_f32_16x16x32_bf16 v[136:139], v[72:75], v[224:227], v[136:139]
    ds_read_b64_tr_b16 v[100:101], v21 offset:32768
    v_mfma_f32_16x16x32_bf16 v[140:143], v[76:79], v[224:227], v[140:143]
    ds_read_b64_tr_b16 v[102:103], v21 offset:34816
    s_waitcnt lgkmcnt(4)
    s_nop 0
    v_mfma_f32_16x16x32_bf16 v[160:163], v[80:83], v[224:227], v[160:163]
    ds_read_b64_tr_b16 v[104:105], v22 offset:32768
    v_mfma_f32_16x16x32_bf16 v[164:167], v[84:87], v[224:227], v[164:167]
    ds_read_b64_tr_b16 v[106:107], v22 offset:34816
    v_mfma_f32_16x16x32_bf16 v[168:171], v[88:91], v[224:227], v[168:171]
    ds_read_b64_tr_b16 v[108:109], v23 offset:32768
    v_mfma_f32_16x16x32_bf16 v[172:175], v[92:95], v[224:227], v[172:175]
    ds_read_b64_tr_b16 v[110:111], v23 offset:34816
    v_mfma_f32_16x16x32_bf16 v[188:191], v[92:95], v[228:231], v[188:191]
    ds_read_b64_tr_b16 v[112:113], v24 offset:32768
    v_mfma_f32_16x16x32_bf16 v[184:187], v[88:91], v[228:231], v[184:187]
    ds_read_b64_tr_b16 v[114:115], v24 offset:34816
    v_mfma_f32_16x16x32_bf16 v[180:183], v[84:87], v[228:231], v[180:183]
    ds_read_b64_tr_b16 v[116:117], v25 offset:32768
    v_mfma_f32_16x16x32_bf16 v[176:179], v[80:83], v[228:231], v[176:179]
    ds_read_b64_tr_b16 v[118:119], v25 offset:34816
    v_mfma_f32_16x16x32_bf16 v[156:159], v[76:79], v[228:231], v[156:159]
    ds_read_b64_tr_b16 v[120:121], v26 offset:32768
    v_mfma_f32_16x16x32_bf16 v[152:155], v[72:75], v[228:231], v[152:155]
    ds_read_b64_tr_b16 v[122:123], v26 offset:34816
    v_mfma_f32_16x16x32_bf16 v[148:151], v[68:71], v[228:231], v[148:151]
    ds_read_b64_tr_b16 v[124:125], v27 offset:32768
    v_mfma_f32_16x16x32_bf16 v[144:147], v[64:67], v[228:231], v[144:147]
    ds_read_b64_tr_b16 v[126:127], v27 offset:34816
    s_waitcnt vmcnt(8) lgkmcnt(8)
    s_nop 0
    v_mfma_f32_16x16x32_bf16 v[128:131], v[96:99], v[232:235], v[128:131]
    ds_read_b64_tr_b16 v[64:65], v20 offset:49152
    v_mfma_f32_16x16x32_bf16 v[132:135], v[100:103], v[232:235], v[132:135]
    ds_read_b64_tr_b16 v[66:67], v20 offset:51200
    v_mfma_f32_16x16x32_bf16 v[136:139], v[104:107], v[232:235], v[136:139]
    ds_read_b64_tr_b16 v[68:69], v21 offset:49152
    v_mfma_f32_16x16x32_bf16 v[140:143], v[108:111], v[232:235], v[140:143]
    ds_read_b64_tr_b16 v[70:71], v21 offset:51200
    s_waitcnt lgkmcnt(4)
    s_nop 0
    v_mfma_f32_16x16x32_bf16 v[160:163], v[112:115], v[232:235], v[160:163]
    ds_read_b64_tr_b16 v[72:73], v22 offset:49152
    v_mfma_f32_16x16x32_bf16 v[164:167], v[116:119], v[232:235], v[164:167]
    ds_read_b64_tr_b16 v[74:75], v22 offset:51200
    v_mfma_f32_16x16x32_bf16 v[168:171], v[120:123], v[232:235], v[168:171]
    ds_read_b64_tr_b16 v[76:77], v23 offset:49152
    v_mfma_f32_16x16x32_bf16 v[172:175], v[124:127], v[232:235], v[172:175]
    ds_read_b64_tr_b16 v[78:79], v23 offset:51200
    v_mfma_f32_16x16x32_bf16 v[188:191], v[124:127], v[236:239], v[188:191]
    ds_read_b64_tr_b16 v[80:81], v24 offset:49152
    v_mfma_f32_16x16x32_bf16 v[184:187], v[120:123], v[236:239], v[184:187]
    ds_read_b64_tr_b16 v[82:83], v24 offset:51200
    v_mfma_f32_16x16x32_bf16 v[180:183], v[116:119], v[236:239], v[180:183]
    ds_read_b64_tr_b16 v[84:85], v25 offset:49152
    v_mfma_f32_16x16x32_bf16 v[176:179], v[112:115], v[236:239], v[176:179]
    ds_read_b64_tr_b16 v[86:87], v25 offset:51200
    v_mfma_f32_16x16x32_bf16 v[156:159], v[108:111], v[236:239], v[156:159]
    ds_read_b64_tr_b16 v[88:89], v26 offset:49152
    v_mfma_f32_16x16x32_bf16 v[152:155], v[104:107], v[236:239], v[152:155]
    ds_read_b64_tr_b16 v[90:91], v26 offset:51200
    v_mfma_f32_16x16x32_bf16 v[148:151], v[100:103], v[236:239], v[148:151]
    ds_read_b64_tr_b16 v[92:93], v27 offset:49152
    v_mfma_f32_16x16x32_bf16 v[144:147], v[96:99], v[236:239], v[144:147]
    ds_read_b64_tr_b16 v[94:95], v27 offset:51200
    s_xor_b32 s42, s66, 8
    s_lshl_b32 s42, s42, 12
    s_add_u32 s42, s42, s40
    buffer_load_dwordx4 v[192:195], v5, s[16:19], s42 offen sc1
    buffer_load_dwordx4 v[196:199], v5, s[16:19], s42 offen offset:256 sc1
    s_xor_b32 s42, s66, 9
    s_lshl_b32 s42, s42, 12
    s_add_u32 s42, s42, s40
    buffer_load_dwordx4 v[200:203], v5, s[16:19], s42 offen sc1
    buffer_load_dwordx4 v[204:207], v5, s[16:19], s42 offen offset:256 sc1
    s_add_u32 m0, s67, 65536
    s_xor_b32 s49, s66, 12
    s_lshl_b32 s49, s49, 17
    s_add_u32 s49, s49, s65
    buffer_load_dwordx4 v3, s[8:11], s49 offen lds
    buffer_load_dwordx4 v4, s[8:11], s49 offen offset:1024 lds
    s_waitcnt vmcnt(12) lgkmcnt(8)
    s_barrier
    s_nop 0
    v_mfma_f32_16x16x32_bf16 v[128:131], v[64:67], v[240:243], v[128:131]
    ds_read_b64_tr_b16 v[96:97], v28 offset:0
    v_mfma_f32_16x16x32_bf16 v[132:135], v[68:71], v[240:243], v[132:135]
    ds_read_b64_tr_b16 v[98:99], v28 offset:2048
    v_mfma_f32_16x16x32_bf16 v[136:139], v[72:75], v[240:243], v[136:139]
    ds_read_b64_tr_b16 v[100:101], v29 offset:0
    v_mfma_f32_16x16x32_bf16 v[140:143], v[76:79], v[240:243], v[140:143]
    ds_read_b64_tr_b16 v[102:103], v29 offset:2048
    s_waitcnt lgkmcnt(4)
    s_nop 0
    v_mfma_f32_16x16x32_bf16 v[160:163], v[80:83], v[240:243], v[160:163]
    ds_read_b64_tr_b16 v[104:105], v30 offset:0
    v_mfma_f32_16x16x32_bf16 v[164:167], v[84:87], v[240:243], v[164:167]
    ds_read_b64_tr_b16 v[106:107], v30 offset:2048
    v_mfma_f32_16x16x32_bf16 v[168:171], v[88:91], v[240:243], v[168:171]
    ds_read_b64_tr_b16 v[108:109], v31 offset:0
    v_mfma_f32_16x16x32_bf16 v[172:175], v[92:95], v[240:243], v[172:175]
    ds_read_b64_tr_b16 v[110:111], v31 offset:2048
    v_mfma_f32_16x16x32_bf16 v[188:191], v[92:95], v[244:247], v[188:191]
    ds_read_b64_tr_b16 v[112:113], v32 offset:0
    v_mfma_f32_16x16x32_bf16 v[184:187], v[88:91], v[244:247], v[184:187]
    ds_read_b64_tr_b16 v[114:115], v32 offset:2048
    v_mfma_f32_16x16x32_bf16 v[180:183], v[84:87], v[244:247], v[180:183]
    ds_read_b64_tr_b16 v[116:117], v33 offset:0
    v_mfma_f32_16x16x32_bf16 v[176:179], v[80:83], v[244:247], v[176:179]
    ds_read_b64_tr_b16 v[118:119], v33 offset:2048
    v_mfma_f32_16x16x32_bf16 v[156:159], v[76:79], v[244:247], v[156:159]
    ds_read_b64_tr_b16 v[120:121], v34 offset:0
    v_mfma_f32_16x16x32_bf16 v[152:155], v[72:75], v[244:247], v[152:155]
    ds_read_b64_tr_b16 v[122:123], v34 offset:2048
    v_mfma_f32_16x16x32_bf16 v[148:151], v[68:71], v[244:247], v[148:151]
    ds_read_b64_tr_b16 v[124:125], v35 offset:0
    v_mfma_f32_16x16x32_bf16 v[144:147], v[64:67], v[244:247], v[144:147]
    ds_read_b64_tr_b16 v[126:127], v35 offset:2048
    s_waitcnt vmcnt(10) lgkmcnt(8)
    s_nop 0
    v_mfma_f32_16x16x32_bf16 v[128:131], v[96:99], v[248:251], v[128:131]
    ds_read_b64_tr_b16 v[64:65], v6 offset:0
    v_mfma_f32_16x16x32_bf16 v[132:135], v[100:103], v[248:251], v[132:135]
    ds_read_b64_tr_b16 v[66:67], v6 offset:2048
    v_mfma_f32_16x16x32_bf16 v[136:139], v[104:107], v[248:251], v[136:139]
    ds_read_b64_tr_b16 v[68:69], v7 offset:0
    v_mfma_f32_16x16x32_bf16 v[140:143], v[108:111], v[248:251], v[140:143]
    ds_read_b64_tr_b16 v[70:71], v7 offset:2048
    s_waitcnt lgkmcnt(4)
    s_nop 0
    v_mfma_f32_16x16x32_bf16 v[160:163], v[112:115], v[248:251], v[160:163]
    ds_read_b64_tr_b16 v[72:73], v8 offset:0
    v_mfma_f32_16x16x32_bf16 v[164:167], v[116:119], v[248:251], v[164:167]
    ds_read_b64_tr_b16 v[74:75], v8 offset:2048
    v_mfma_f32_16x16x32_bf16 v[168:171], v[120:123], v[248:251], v[168:171]
    ds_read_b64_tr_b16 v[76:77], v9 offset:0
    v_mfma_f32_16x16x32_bf16 v[172:175], v[124:127], v[248:251], v[172:175]
    ds_read_b64_tr_b16 v[78:79], v9 offset:2048
    v_mfma_f32_16x16x32_bf16 v[188:191], v[124:127], v[252:255], v[188:191]
    ds_read_b64_tr_b16 v[80:81], v10 offset:0
    v_mfma_f32_16x16x32_bf16 v[184:187], v[120:123], v[252:255], v[184:187]
    ds_read_b64_tr_b16 v[82:83], v10 offset:2048
    v_mfma_f32_16x16x32_bf16 v[180:183], v[116:119], v[252:255], v[180:183]
    ds_read_b64_tr_b16 v[84:85], v11 offset:0
    v_mfma_f32_16x16x32_bf16 v[176:179], v[112:115], v[252:255], v[176:179]
    ds_read_b64_tr_b16 v[86:87], v11 offset:2048
    v_mfma_f32_16x16x32_bf16 v[156:159], v[108:111], v[252:255], v[156:159]
    ds_read_b64_tr_b16 v[88:89], v12 offset:0
    v_mfma_f32_16x16x32_bf16 v[152:155], v[104:107], v[252:255], v[152:155]
    ds_read_b64_tr_b16 v[90:91], v12 offset:2048
    v_mfma_f32_16x16x32_bf16 v[148:151], v[100:103], v[252:255], v[148:151]
    ds_read_b64_tr_b16 v[92:93], v13 offset:0
    v_mfma_f32_16x16x32_bf16 v[144:147], v[96:99], v[252:255], v[144:147]
    ds_read_b64_tr_b16 v[94:95], v13 offset:2048
    s_xor_b32 s42, s66, 10
    s_lshl_b32 s42, s42, 12
    s_add_u32 s42, s42, s40
    buffer_load_dwordx4 v[208:211], v5, s[16:19], s42 offen sc1
    buffer_load_dwordx4 v[212:215], v5, s[16:19], s42 offen offset:256 sc1
    s_xor_b32 s42, s66, 11
    s_lshl_b32 s42, s42, 12
    s_add_u32 s42, s42, s40
    buffer_load_dwordx4 v[216:219], v5, s[16:19], s42 offen sc1
    buffer_load_dwordx4 v[220:223], v5, s[16:19], s42 offen offset:256 sc1
    s_add_u32 m0, s67, 81920
    s_xor_b32 s49, s66, 13
    s_lshl_b32 s49, s49, 17
    s_add_u32 s49, s49, s65
    buffer_load_dwordx4 v3, s[8:11], s49 offen lds
    buffer_load_dwordx4 v4, s[8:11], s49 offen offset:1024 lds
    s_add_u32 m0, s67, 98304
    s_xor_b32 s49, s66, 14
    s_lshl_b32 s49, s49, 17
    s_add_u32 s49, s49, s65
    buffer_load_dwordx4 v3, s[8:11], s49 offen lds
    buffer_load_dwordx4 v4, s[8:11], s49 offen offset:1024 lds
    s_waitcnt vmcnt(12) lgkmcnt(8)
    s_barrier
    v_mfma_f32_16x16x32_bf16 v[128:131], v[64:67], v[192:195], v[128:131]
    ds_read_b64_tr_b16 v[96:97], v6 offset:16384
    v_mfma_f32_16x16x32_bf16 v[132:135], v[68:71], v[192:195], v[132:135]
    ds_read_b64_tr_b16 v[98:99], v6 offset:18432
    v_mfma_f32_16x16x32_bf16 v[136:139], v[72:75], v[192:195], v[136:139]
    ds_read_b64_tr_b16 v[100:101], v7 offset:16384
    v_mfma_f32_16x16x32_bf16 v[140:143], v[76:79], v[192:195], v[140:143]
    ds_read_b64_tr_b16 v[102:103], v7 offset:18432
    s_waitcnt lgkmcnt(4)
    s_nop 0
    v_mfma_f32_16x16x32_bf16 v[160:163], v[80:83], v[192:195], v[160:163]
    ds_read_b64_tr_b16 v[104:105], v8 offset:16384
    v_mfma_f32_16x16x32_bf16 v[164:167], v[84:87], v[192:195], v[164:167]
    ds_read_b64_tr_b16 v[106:107], v8 offset:18432
    v_mfma_f32_16x16x32_bf16 v[168:171], v[88:91], v[192:195], v[168:171]
    ds_read_b64_tr_b16 v[108:109], v9 offset:16384
    v_mfma_f32_16x16x32_bf16 v[172:175], v[92:95], v[192:195], v[172:175]
    ds_read_b64_tr_b16 v[110:111], v9 offset:18432
    v_mfma_f32_16x16x32_bf16 v[188:191], v[92:95], v[196:199], v[188:191]
    ds_read_b64_tr_b16 v[112:113], v10 offset:16384
    v_mfma_f32_16x16x32_bf16 v[184:187], v[88:91], v[196:199], v[184:187]
    ds_read_b64_tr_b16 v[114:115], v10 offset:18432
    v_mfma_f32_16x16x32_bf16 v[180:183], v[84:87], v[196:199], v[180:183]
    ds_read_b64_tr_b16 v[116:117], v11 offset:16384
    v_mfma_f32_16x16x32_bf16 v[176:179], v[80:83], v[196:199], v[176:179]
    ds_read_b64_tr_b16 v[118:119], v11 offset:18432
    v_mfma_f32_16x16x32_bf16 v[156:159], v[76:79], v[196:199], v[156:159]
    ds_read_b64_tr_b16 v[120:121], v12 offset:16384
    v_mfma_f32_16x16x32_bf16 v[152:155], v[72:75], v[196:199], v[152:155]
    ds_read_b64_tr_b16 v[122:123], v12 offset:18432
    v_mfma_f32_16x16x32_bf16 v[148:151], v[68:71], v[196:199], v[148:151]
    ds_read_b64_tr_b16 v[124:125], v13 offset:16384
    v_mfma_f32_16x16x32_bf16 v[144:147], v[64:67], v[196:199], v[144:147]
    ds_read_b64_tr_b16 v[126:127], v13 offset:18432
    s_waitcnt vmcnt(10) lgkmcnt(8)
    s_nop 0
    v_mfma_f32_16x16x32_bf16 v[128:131], v[96:99], v[200:203], v[128:131]
    ds_read_b64_tr_b16 v[64:65], v6 offset:32768
    v_mfma_f32_16x16x32_bf16 v[132:135], v[100:103], v[200:203], v[132:135]
    ds_read_b64_tr_b16 v[66:67], v6 offset:34816
    v_mfma_f32_16x16x32_bf16 v[136:139], v[104:107], v[200:203], v[136:139]
    ds_read_b64_tr_b16 v[68:69], v7 offset:32768
    v_mfma_f32_16x16x32_bf16 v[140:143], v[108:111], v[200:203], v[140:143]
    ds_read_b64_tr_b16 v[70:71], v7 offset:34816
    s_waitcnt lgkmcnt(4)
    s_nop 0
    v_mfma_f32_16x16x32_bf16 v[160:163], v[112:115], v[200:203], v[160:163]
    ds_read_b64_tr_b16 v[72:73], v8 offset:32768
    v_mfma_f32_16x16x32_bf16 v[164:167], v[116:119], v[200:203], v[164:167]
    ds_read_b64_tr_b16 v[74:75], v8 offset:34816
    v_mfma_f32_16x16x32_bf16 v[168:171], v[120:123], v[200:203], v[168:171]
    ds_read_b64_tr_b16 v[76:77], v9 offset:32768
    v_mfma_f32_16x16x32_bf16 v[172:175], v[124:127], v[200:203], v[172:175]
    ds_read_b64_tr_b16 v[78:79], v9 offset:34816
    v_mfma_f32_16x16x32_bf16 v[188:191], v[124:127], v[204:207], v[188:191]
    ds_read_b64_tr_b16 v[80:81], v10 offset:32768
    v_mfma_f32_16x16x32_bf16 v[184:187], v[120:123], v[204:207], v[184:187]
    ds_read_b64_tr_b16 v[82:83], v10 offset:34816
    v_mfma_f32_16x16x32_bf16 v[180:183], v[116:119], v[204:207], v[180:183]
    ds_read_b64_tr_b16 v[84:85], v11 offset:32768
    v_mfma_f32_16x16x32_bf16 v[176:179], v[112:115], v[204:207], v[176:179]
    ds_read_b64_tr_b16 v[86:87], v11 offset:34816
    v_mfma_f32_16x16x32_bf16 v[156:159], v[108:111], v[204:207], v[156:159]
    ds_read_b64_tr_b16 v[88:89], v12 offset:32768
    v_mfma_f32_16x16x32_bf16 v[152:155], v[104:107], v[204:207], v[152:155]
    ds_read_b64_tr_b16 v[90:91], v12 offset:34816
    v_mfma_f32_16x16x32_bf16 v[148:151], v[100:103], v[204:207], v[148:151]
    ds_read_b64_tr_b16 v[92:93], v13 offset:32768
    v_mfma_f32_16x16x32_bf16 v[144:147], v[96:99], v[204:207], v[144:147]
    ds_read_b64_tr_b16 v[94:95], v13 offset:34816
    s_xor_b32 s42, s66, 12
    s_lshl_b32 s42, s42, 12
    s_add_u32 s42, s42, s40
    buffer_load_dwordx4 v[224:227], v5, s[16:19], s42 offen sc1
    buffer_load_dwordx4 v[228:231], v5, s[16:19], s42 offen offset:256 sc1
    s_xor_b32 s42, s66, 13
    s_lshl_b32 s42, s42, 12
    s_add_u32 s42, s42, s40
    buffer_load_dwordx4 v[232:235], v5, s[16:19], s42 offen sc1
    buffer_load_dwordx4 v[236:239], v5, s[16:19], s42 offen offset:256 sc1
    s_xor_b32 s42, s66, 14
    s_lshl_b32 s42, s42, 12
    s_add_u32 s42, s42, s40
    buffer_load_dwordx4 v[240:243], v5, s[16:19], s42 offen sc1
    buffer_load_dwordx4 v[244:247], v5, s[16:19], s42 offen offset:256 sc1
    s_xor_b32 s42, s66, 15
    s_lshl_b32 s42, s42, 12
    s_add_u32 s42, s42, s40
    buffer_load_dwordx4 v[248:251], v5, s[16:19], s42 offen sc1
    buffer_load_dwordx4 v[252:255], v5, s[16:19], s42 offen offset:256 sc1
    s_add_u32 m0, s67, 114688
    s_xor_b32 s49, s66, 15
    s_lshl_b32 s49, s49, 17
    s_add_u32 s49, s49, s65
    buffer_load_dwordx4 v3, s[8:11], s49 offen lds
    buffer_load_dwordx4 v4, s[8:11], s49 offen offset:1024 lds
    s_waitcnt vmcnt(12) lgkmcnt(8)
    s_barrier
    s_nop 0
    v_mfma_f32_16x16x32_bf16 v[128:131], v[64:67], v[208:211], v[128:131]
    ds_read_b64_tr_b16 v[96:97], v6 offset:49152
    v_mfma_f32_16x16x32_bf16 v[132:135], v[68:71], v[208:211], v[132:135]
    ds_read_b64_tr_b16 v[98:99], v6 offset:51200
    v_mfma_f32_16x16x32_bf16 v[136:139], v[72:75], v[208:211], v[136:139]
    ds_read_b64_tr_b16 v[100:101], v7 offset:49152
    v_mfma_f32_16x16x32_bf16 v[140:143], v[76:79], v[208:211], v[140:143]
    ds_read_b64_tr_b16 v[102:103], v7 offset:51200
    s_waitcnt lgkmcnt(4)
    s_nop 0
    v_mfma_f32_16x16x32_bf16 v[160:163], v[80:83], v[208:211], v[160:163]
    ds_read_b64_tr_b16 v[104:105], v8 offset:49152
    v_mfma_f32_16x16x32_bf16 v[164:167], v[84:87], v[208:211], v[164:167]
    ds_read_b64_tr_b16 v[106:107], v8 offset:51200
    v_mfma_f32_16x16x32_bf16 v[168:171], v[88:91], v[208:211], v[168:171]
    ds_read_b64_tr_b16 v[108:109], v9 offset:49152
    v_mfma_f32_16x16x32_bf16 v[172:175], v[92:95], v[208:211], v[172:175]
    ds_read_b64_tr_b16 v[110:111], v9 offset:51200
    v_mfma_f32_16x16x32_bf16 v[188:191], v[92:95], v[212:215], v[188:191]
    ds_read_b64_tr_b16 v[112:113], v10 offset:49152
    v_mfma_f32_16x16x32_bf16 v[184:187], v[88:91], v[212:215], v[184:187]
    ds_read_b64_tr_b16 v[114:115], v10 offset:51200
    v_mfma_f32_16x16x32_bf16 v[180:183], v[84:87], v[212:215], v[180:183]
    ds_read_b64_tr_b16 v[116:117], v11 offset:49152
    v_mfma_f32_16x16x32_bf16 v[176:179], v[80:83], v[212:215], v[176:179]
    ds_read_b64_tr_b16 v[118:119], v11 offset:51200
    v_mfma_f32_16x16x32_bf16 v[156:159], v[76:79], v[212:215], v[156:159]
    ds_read_b64_tr_b16 v[120:121], v12 offset:49152
    v_mfma_f32_16x16x32_bf16 v[152:155], v[72:75], v[212:215], v[152:155]
    ds_read_b64_tr_b16 v[122:123], v12 offset:51200
    v_mfma_f32_16x16x32_bf16 v[148:151], v[68:71], v[212:215], v[148:151]
    ds_read_b64_tr_b16 v[124:125], v13 offset:49152
    v_mfma_f32_16x16x32_bf16 v[144:147], v[64:67], v[212:215], v[144:147]
    ds_read_b64_tr_b16 v[126:127], v13 offset:51200
    s_waitcnt vmcnt(14) lgkmcnt(8)
    s_nop 0
    v_mfma_f32_16x16x32_bf16 v[128:131], v[96:99], v[216:219], v[128:131]
    ds_read_b64_tr_b16 v[64:65], v24 offset:0
    v_mfma_f32_16x16x32_bf16 v[132:135], v[100:103], v[216:219], v[132:135]
    ds_read_b64_tr_b16 v[66:67], v24 offset:2048
    v_mfma_f32_16x16x32_bf16 v[136:139], v[104:107], v[216:219], v[136:139]
    ds_read_b64_tr_b16 v[68:69], v25 offset:0
    v_mfma_f32_16x16x32_bf16 v[140:143], v[108:111], v[216:219], v[140:143]
    ds_read_b64_tr_b16 v[70:71], v25 offset:2048
    s_waitcnt lgkmcnt(4)
    s_nop 0
    v_mfma_f32_16x16x32_bf16 v[160:163], v[112:115], v[216:219], v[160:163]
    ds_read_b64_tr_b16 v[72:73], v26 offset:0
    v_mfma_f32_16x16x32_bf16 v[164:167], v[116:119], v[216:219], v[164:167]
    ds_read_b64_tr_b16 v[74:75], v26 offset:2048
    v_mfma_f32_16x16x32_bf16 v[168:171], v[120:123], v[216:219], v[168:171]
    ds_read_b64_tr_b16 v[76:77], v27 offset:0
    v_mfma_f32_16x16x32_bf16 v[172:175], v[124:127], v[216:219], v[172:175]
    ds_read_b64_tr_b16 v[78:79], v27 offset:2048
    v_mfma_f32_16x16x32_bf16 v[188:191], v[124:127], v[220:223], v[188:191]
    ds_read_b64_tr_b16 v[80:81], v24 offset:16384
    v_mfma_f32_16x16x32_bf16 v[184:187], v[120:123], v[220:223], v[184:187]
    ds_read_b64_tr_b16 v[82:83], v24 offset:18432
    v_mfma_f32_16x16x32_bf16 v[180:183], v[116:119], v[220:223], v[180:183]
    ds_read_b64_tr_b16 v[84:85], v25 offset:16384
    v_mfma_f32_16x16x32_bf16 v[176:179], v[112:115], v[220:223], v[176:179]
    ds_read_b64_tr_b16 v[86:87], v25 offset:18432
    v_mfma_f32_16x16x32_bf16 v[156:159], v[108:111], v[220:223], v[156:159]
    ds_read_b64_tr_b16 v[88:89], v26 offset:16384
    v_mfma_f32_16x16x32_bf16 v[152:155], v[104:107], v[220:223], v[152:155]
    ds_read_b64_tr_b16 v[90:91], v26 offset:18432
    v_mfma_f32_16x16x32_bf16 v[148:151], v[100:103], v[220:223], v[148:151]
    ds_read_b64_tr_b16 v[92:93], v27 offset:16384
    v_mfma_f32_16x16x32_bf16 v[144:147], v[96:99], v[220:223], v[144:147]
    ds_read_b64_tr_b16 v[94:95], v27 offset:18432
    s_branch G3JOIN_105
.p2align 12
G3HI_104:
    s_waitcnt vmcnt(6) lgkmcnt(0)
    s_nop 0
    v_mfma_f32_16x16x32_bf16 v[128:131], v[64:67], v[192:195], 0
    ds_read_b64_tr_b16 v[96:97], v6 offset:49152
    v_mfma_f32_16x16x32_bf16 v[132:135], v[68:71], v[192:195], 0
    ds_read_b64_tr_b16 v[98:99], v6 offset:51200
    v_mfma_f32_16x16x32_bf16 v[136:139], v[72:75], v[192:195], 0
    ds_read_b64_tr_b16 v[100:101], v7 offset:49152
    v_mfma_f32_16x16x32_bf16 v[140:143], v[76:79], v[192:195], 0
    ds_read_b64_tr_b16 v[102:103], v7 offset:51200
    v_mfma_f32_16x16x32_bf16 v[160:163], v[80:83], v[192:195], 0
    ds_read_b64_tr_b16 v[104:105], v8 offset:49152
    v_mfma_f32_16x16x32_bf16 v[164:167], v[84:87], v[192:195], 0
    ds_read_b64_tr_b16 v[106:107], v8 offset:51200
    v_mfma_f32_16x16x32_bf16 v[168:171], v[88:91], v[192:195], 0
    ds_read_b64_tr_b16 v[108:109], v9 offset:49152
    v_mfma_f32_16x16x32_bf16 v[172:175], v[92:95], v[192:195], 0
    ds_read_b64_tr_b16 v[110:111], v9 offset:51200
    v_mfma_f32_16x16x32_bf16 v[188:191], v[92:95], v[196:199], 0
    ds_read_b64_tr_b16 v[112:113], v10 offset:49152
    v_mfma_f32_16x16x32_bf16 v[184:187], v[88:91], v[196:199], 0
    ds_read_b64_tr_b16 v[114:115], v10 offset:51200
    v_mfma_f32_16x16x32_bf16 v[180:183], v[84:87], v[196:199], 0
    ds_read_b64_tr_b16 v[116:117], v11 offset:49152
    v_mfma_f32_16x16x32_bf16 v[176:179], v[80:83], v[196:199], 0
    ds_read_b64_tr_b16 v[118:119], v11 offset:51200
    v_mfma_f32_16x16x32_bf16 v[156:159], v[76:79], v[196:199], 0
    ds_read_b64_tr_b16 v[120:121], v12 offset:49152
    v_mfma_f32_16x16x32_bf16 v[152:155], v[72:75], v[196:199], 0
    ds_read_b64_tr_b16 v[122:123], v12 offset:51200
    v_mfma_f32_16x16x32_bf16 v[148:151], v[68:71], v[196:199], 0
    ds_read_b64_tr_b16 v[124:125], v13 offset:49152
    v_mfma_f32_16x16x32_bf16 v[144:147], v[64:67], v[196:199], 0
    ds_read_b64_tr_b16 v[126:127], v13 offset:51200
    s_waitcnt vmcnt(4) lgkmcnt(8)
    s_nop 0
    v_mfma_f32_16x16x32_bf16 v[128:131], v[96:99], v[200:203], v[128:131]
    ds_read_b64_tr_b16 v[64:65], v28 offset:16384
    v_mfma_f32_16x16x32_bf16 v[132:135], v[100:103], v[200:203], v[132:135]
    ds_read_b64_tr_b16 v[66:67], v28 offset:18432
    v_mfma_f32_16x16x32_bf16 v[136:139], v[104:107], v[200:203], v[136:139]
    ds_read_b64_tr_b16 v[68:69], v29 offset:16384
    v_mfma_f32_16x16x32_bf16 v[140:143], v[108:111], v[200:203], v[140:143]
    ds_read_b64_tr_b16 v[70:71], v29 offset:18432
    s_waitcnt lgkmcnt(4)
    s_nop 0
    v_mfma_f32_16x16x32_bf16 v[160:163], v[112:115], v[200:203], v[160:163]
    ds_read_b64_tr_b16 v[72:73], v30 offset:16384
    v_mfma_f32_16x16x32_bf16 v[164:167], v[116:119], v[200:203], v[164:167]
    ds_read_b64_tr_b16 v[74:75], v30 offset:18432
    v_mfma_f32_16x16x32_bf16 v[168:171], v[120:123], v[200:203], v[168:171]
    ds_read_b64_tr_b16 v[76:77], v31 offset:16384
    v_mfma_f32_16x16x32_bf16 v[172:175], v[124:127], v[200:203], v[172:175]
    ds_read_b64_tr_b16 v[78:79], v31 offset:18432
    v_mfma_f32_16x16x32_bf16 v[188:191], v[124:127], v[204:207], v[188:191]
    ds_read_b64_tr_b16 v[80:81], v32 offset:16384
    v_mfma_f32_16x16x32_bf16 v[184:187], v[120:123], v[204:207], v[184:187]
    ds_read_b64_tr_b16 v[82:83], v32 offset:18432
    v_mfma_f32_16x16x32_bf16 v[180:183], v[116:119], v[204:207], v[180:183]
    ds_read_b64_tr_b16 v[84:85], v33 offset:16384
    v_mfma_f32_16x16x32_bf16 v[176:179], v[112:115], v[204:207], v[176:179]
    ds_read_b64_tr_b16 v[86:87], v33 offset:18432
    v_mfma_f32_16x16x32_bf16 v[156:159], v[108:111], v[204:207], v[156:159]
    ds_read_b64_tr_b16 v[88:89], v34 offset:16384
    v_mfma_f32_16x16x32_bf16 v[152:155], v[104:107], v[204:207], v[152:155]
    ds_read_b64_tr_b16 v[90:91], v34 offset:18432
    v_mfma_f32_16x16x32_bf16 v[148:151], v[100:103], v[204:207], v[148:151]
    ds_read_b64_tr_b16 v[92:93], v35 offset:16384
    v_mfma_f32_16x16x32_bf16 v[144:147], v[96:99], v[204:207], v[144:147]
    ds_read_b64_tr_b16 v[94:95], v35 offset:18432
    s_waitcnt vmcnt(63) lgkmcnt(8)
    s_barrier
    s_xor_b32 s42, s66, 4
    s_lshl_b32 s42, s42, 12
    s_add_u32 s42, s42, s40
    buffer_load_dwordx4 v[224:227], v5, s[16:19], s42 offen sc1
    buffer_load_dwordx4 v[228:231], v5, s[16:19], s42 offen offset:256 sc1
    s_xor_b32 s42, s66, 5
    s_lshl_b32 s42, s42, 12
    s_add_u32 s42, s42, s40
    buffer_load_dwordx4 v[232:235], v5, s[16:19], s42 offen sc1
    buffer_load_dwordx4 v[236:239], v5, s[16:19], s42 offen offset:256 sc1
    s_add_u32 m0, s67, 32768
    s_xor_b32 s49, s66, 10
    s_lshl_b32 s49, s49, 17
    s_add_u32 s49, s49, s65
    buffer_load_dwordx4 v3, s[8:11], s49 offen lds
    buffer_load_dwordx4 v4, s[8:11], s49 offen offset:1024 lds
    s_add_u32 m0, s67, 49152
    s_xor_b32 s49, s66, 11
    s_lshl_b32 s49, s49, 17
    s_add_u32 s49, s49, s65
    buffer_load_dwordx4 v3, s[8:11], s49 offen lds
    buffer_load_dwordx4 v4, s[8:11], s49 offen offset:1024 lds
    s_waitcnt vmcnt(10)
    s_nop 0
    v_mfma_f32_16x16x32_bf16 v[128:131], v[64:67], v[208:211], v[128:131]
    ds_read_b64_tr_b16 v[96:97], v20 offset:0
    v_mfma_f32_16x16x32_bf16 v[132:135], v[68:71], v[208:211], v[132:135]
    ds_read_b64_tr_b16 v[98:99], v20 offset:2048
    v_mfma_f32_16x16x32_bf16 v[136:139], v[72:75], v[208:211], v[136:139]
    ds_read_b64_tr_b16 v[100:101], v21 offset:0
    v_mfma_f32_16x16x32_bf16 v[140:143], v[76:79], v[208:211], v[140:143]
    ds_read_b64_tr_b16 v[102:103], v21 offset:2048
    s_waitcnt lgkmcnt(4)
    s_nop 0
    v_mfma_f32_16x16x32_bf16 v[160:163], v[80:83], v[208:211], v[160:163]
    ds_read_b64_tr_b16 v[104:105], v22 offset:0
    v_mfma_f32_16x16x32_bf16 v[164:167], v[84:87], v[208:211], v[164:167]
    ds_read_b64_tr_b16 v[106:107], v22 offset:2048
    v_mfma_f32_16x16x32_bf16 v[168:171], v[88:91], v[208:211], v[168:171]
    ds_read_b64_tr_b16 v[108:109], v23 offset:0
    v_mfma_f32_16x16x32_bf16 v[172:175], v[92:95], v[208:211], v[172:175]
    ds_read_b64_tr_b16 v[110:111], v23 offset:2048
    v_mfma_f32_16x16x32_bf16 v[188:191], v[92:95], v[212:215], v[188:191]
    ds_read_b64_tr_b16 v[112:113], v24 offset:0
    v_mfma_f32_16x16x32_bf16 v[184:187], v[88:91], v[212:215], v[184:187]
    ds_read_b64_tr_b16 v[114:115], v24 offset:2048
    v_mfma_f32_16x16x32_bf16 v[180:183], v[84:87], v[212:215], v[180:183]
    ds_read_b64_tr_b16 v[116:117], v25 offset:0
    v_mfma_f32_16x16x32_bf16 v[176:179], v[80:83], v[212:215], v[176:179]
    ds_read_b64_tr_b16 v[118:119], v25 offset:2048
    v_mfma_f32_16x16x32_bf16 v[156:159], v[76:79], v[212:215], v[156:159]
    ds_read_b64_tr_b16 v[120:121], v26 offset:0
    v_mfma_f32_16x16x32_bf16 v[152:155], v[72:75], v[212:215], v[152:155]
    ds_read_b64_tr_b16 v[122:123], v26 offset:2048
    v_mfma_f32_16x16x32_bf16 v[148:151], v[68:71], v[212:215], v[148:151]
    ds_read_b64_tr_b16 v[124:125], v27 offset:0
    v_mfma_f32_16x16x32_bf16 v[144:147], v[64:67], v[212:215], v[144:147]
    ds_read_b64_tr_b16 v[126:127], v27 offset:2048
    s_waitcnt vmcnt(8) lgkmcnt(8)
    s_nop 0
    v_mfma_f32_16x16x32_bf16 v[128:131], v[96:99], v[216:219], v[128:131]
    ds_read_b64_tr_b16 v[64:65], v20 offset:16384
    v_mfma_f32_16x16x32_bf16 v[132:135], v[100:103], v[216:219], v[132:135]
    ds_read_b64_tr_b16 v[66:67], v20 offset:18432
    v_mfma_f32_16x16x32_bf16 v[136:139], v[104:107], v[216:219], v[136:139]
    ds_read_b64_tr_b16 v[68:69], v21 offset:16384
    v_mfma_f32_16x16x32_bf16 v[140:143], v[108:111], v[216:219], v[140:143]
    ds_read_b64_tr_b16 v[70:71], v21 offset:18432
    s_waitcnt lgkmcnt(4)
    s_nop 0
    v_mfma_f32_16x16x32_bf16 v[160:163], v[112:115], v[216:219], v[160:163]
    ds_read_b64_tr_b16 v[72:73], v22 offset:16384
    v_mfma_f32_16x16x32_bf16 v[164:167], v[116:119], v[216:219], v[164:167]
    ds_read_b64_tr_b16 v[74:75], v22 offset:18432
    v_mfma_f32_16x16x32_bf16 v[168:171], v[120:123], v[216:219], v[168:171]
    ds_read_b64_tr_b16 v[76:77], v23 offset:16384
    v_mfma_f32_16x16x32_bf16 v[172:175], v[124:127], v[216:219], v[172:175]
    ds_read_b64_tr_b16 v[78:79], v23 offset:18432
    v_mfma_f32_16x16x32_bf16 v[188:191], v[124:127], v[220:223], v[188:191]
    ds_read_b64_tr_b16 v[80:81], v24 offset:16384
    v_mfma_f32_16x16x32_bf16 v[184:187], v[120:123], v[220:223], v[184:187]
    ds_read_b64_tr_b16 v[82:83], v24 offset:18432
    v_mfma_f32_16x16x32_bf16 v[180:183], v[116:119], v[220:223], v[180:183]
    ds_read_b64_tr_b16 v[84:85], v25 offset:16384
    v_mfma_f32_16x16x32_bf16 v[176:179], v[112:115], v[220:223], v[176:179]
    ds_read_b64_tr_b16 v[86:87], v25 offset:18432
    v_mfma_f32_16x16x32_bf16 v[156:159], v[108:111], v[220:223], v[156:159]
    ds_read_b64_tr_b16 v[88:89], v26 offset:16384
    v_mfma_f32_16x16x32_bf16 v[152:155], v[104:107], v[220:223], v[152:155]
    ds_read_b64_tr_b16 v[90:91], v26 offset:18432
    v_mfma_f32_16x16x32_bf16 v[148:151], v[100:103], v[220:223], v[148:151]
    ds_read_b64_tr_b16 v[92:93], v27 offset:16384
    v_mfma_f32_16x16x32_bf16 v[144:147], v[96:99], v[220:223], v[144:147]
    ds_read_b64_tr_b16 v[94:95], v27 offset:18432
    s_waitcnt vmcnt(16) lgkmcnt(8)
    s_barrier
    s_xor_b32 s42, s66, 6
    s_lshl_b32 s42, s42, 12
    s_add_u32 s42, s42, s40
    buffer_load_dwordx4 v[240:243], v5, s[16:19], s42 offen sc1
    buffer_load_dwordx4 v[244:247], v5, s[16:19], s42 offen offset:256 sc1
    s_xor_b32 s42, s66, 7
    s_lshl_b32 s42, s42, 12
    s_add_u32 s42, s42, s40
    buffer_load_dwordx4 v[248:251], v5, s[16:19], s42 offen sc1
    buffer_load_dwordx4 v[252:255], v5, s[16:19], s42 offen offset:256 sc1
    s_add_u32 m0, s67, 65536
    s_xor_b32 s49, s66, 12
    s_lshl_b32 s49, s49, 17
    s_add_u32 s49, s49, s65
    buffer_load_dwordx4 v3, s[8:11], s49 offen lds
    buffer_load_dwordx4 v4, s[8:11], s49 offen offset:1024 lds
    s_waitcnt vmcnt(12)
    v_mfma_f32_16x16x32_bf16 v[128:131], v[64:67], v[224:227], v[128:131]
    ds_read_b64_tr_b16 v[96:97], v20 offset:32768
    v_mfma_f32_16x16x32_bf16 v[132:135], v[68:71], v[224:227], v[132:135]
    ds_read_b64_tr_b16 v[98:99], v20 offset:34816
    v_mfma_f32_16x16x32_bf16 v[136:139], v[72:75], v[224:227], v[136:139]
    ds_read_b64_tr_b16 v[100:101], v21 offset:32768
    v_mfma_f32_16x16x32_bf16 v[140:143], v[76:79], v[224:227], v[140:143]
    ds_read_b64_tr_b16 v[102:103], v21 offset:34816
    s_waitcnt lgkmcnt(4)
    s_nop 0
    v_mfma_f32_16x16x32_bf16 v[160:163], v[80:83], v[224:227], v[160:163]
    ds_read_b64_tr_b16 v[104:105], v22 offset:32768
    v_mfma_f32_16x16x32_bf16 v[164:167], v[84:87], v[224:227], v[164:167]
    ds_read_b64_tr_b16 v[106:107], v22 offset:34816
    v_mfma_f32_16x16x32_bf16 v[168:171], v[88:91], v[224:227], v[168:171]
    ds_read_b64_tr_b16 v[108:109], v23 offset:32768
    v_mfma_f32_16x16x32_bf16 v[172:175], v[92:95], v[224:227], v[172:175]
    ds_read_b64_tr_b16 v[110:111], v23 offset:34816
    v_mfma_f32_16x16x32_bf16 v[188:191], v[92:95], v[228:231], v[188:191]
    ds_read_b64_tr_b16 v[112:113], v24 offset:32768
    v_mfma_f32_16x16x32_bf16 v[184:187], v[88:91], v[228:231], v[184:187]
    ds_read_b64_tr_b16 v[114:115], v24 offset:34816
    v_mfma_f32_16x16x32_bf16 v[180:183], v[84:87], v[228:231], v[180:183]
    ds_read_b64_tr_b16 v[116:117], v25 offset:32768
    v_mfma_f32_16x16x32_bf16 v[176:179], v[80:83], v[228:231], v[176:179]
    ds_read_b64_tr_b16 v[118:119], v25 offset:34816
    v_mfma_f32_16x16x32_bf16 v[156:159], v[76:79], v[228:231], v[156:159]
    ds_read_b64_tr_b16 v[120:121], v26 offset:32768
    v_mfma_f32_16x16x32_bf16 v[152:155], v[72:75], v[228:231], v[152:155]
    ds_read_b64_tr_b16 v[122:123], v26 offset:34816
    v_mfma_f32_16x16x32_bf16 v[148:151], v[68:71], v[228:231], v[148:151]
    ds_read_b64_tr_b16 v[124:125], v27 offset:32768
    v_mfma_f32_16x16x32_bf16 v[144:147], v[64:67], v[228:231], v[144:147]
    ds_read_b64_tr_b16 v[126:127], v27 offset:34816
    s_waitcnt vmcnt(10) lgkmcnt(8)
    s_nop 0
    v_mfma_f32_16x16x32_bf16 v[128:131], v[96:99], v[232:235], v[128:131]
    ds_read_b64_tr_b16 v[64:65], v20 offset:49152
    v_mfma_f32_16x16x32_bf16 v[132:135], v[100:103], v[232:235], v[132:135]
    ds_read_b64_tr_b16 v[66:67], v20 offset:51200
    v_mfma_f32_16x16x32_bf16 v[136:139], v[104:107], v[232:235], v[136:139]
    ds_read_b64_tr_b16 v[68:69], v21 offset:49152
    v_mfma_f32_16x16x32_bf16 v[140:143], v[108:111], v[232:235], v[140:143]
    ds_read_b64_tr_b16 v[70:71], v21 offset:51200
    s_waitcnt lgkmcnt(4)
    s_nop 0
    v_mfma_f32_16x16x32_bf16 v[160:163], v[112:115], v[232:235], v[160:163]
    ds_read_b64_tr_b16 v[72:73], v22 offset:49152
    v_mfma_f32_16x16x32_bf16 v[164:167], v[116:119], v[232:235], v[164:167]
    ds_read_b64_tr_b16 v[74:75], v22 offset:51200
    v_mfma_f32_16x16x32_bf16 v[168:171], v[120:123], v[232:235], v[168:171]
    ds_read_b64_tr_b16 v[76:77], v23 offset:49152
    v_mfma_f32_16x16x32_bf16 v[172:175], v[124:127], v[232:235], v[172:175]
    ds_read_b64_tr_b16 v[78:79], v23 offset:51200
    v_mfma_f32_16x16x32_bf16 v[188:191], v[124:127], v[236:239], v[188:191]
    ds_read_b64_tr_b16 v[80:81], v24 offset:49152
    v_mfma_f32_16x16x32_bf16 v[184:187], v[120:123], v[236:239], v[184:187]
    ds_read_b64_tr_b16 v[82:83], v24 offset:51200
    v_mfma_f32_16x16x32_bf16 v[180:183], v[116:119], v[236:239], v[180:183]
    ds_read_b64_tr_b16 v[84:85], v25 offset:49152
    v_mfma_f32_16x16x32_bf16 v[176:179], v[112:115], v[236:239], v[176:179]
    ds_read_b64_tr_b16 v[86:87], v25 offset:51200
    v_mfma_f32_16x16x32_bf16 v[156:159], v[108:111], v[236:239], v[156:159]
    ds_read_b64_tr_b16 v[88:89], v26 offset:49152
    v_mfma_f32_16x16x32_bf16 v[152:155], v[104:107], v[236:239], v[152:155]
    ds_read_b64_tr_b16 v[90:91], v26 offset:51200
    v_mfma_f32_16x16x32_bf16 v[148:151], v[100:103], v[236:239], v[148:151]
    ds_read_b64_tr_b16 v[92:93], v27 offset:49152
    v_mfma_f32_16x16x32_bf16 v[144:147], v[96:99], v[236:239], v[144:147]
    ds_read_b64_tr_b16 v[94:95], v27 offset:51200
    s_waitcnt vmcnt(63) lgkmcnt(8)
    s_barrier
    s_xor_b32 s42, s66, 8
    s_lshl_b32 s42, s42, 12
    s_add_u32 s42, s42, s40
    buffer_load_dwordx4 v[192:195], v5, s[16:19], s42 offen sc1
    buffer_load_dwordx4 v[196:199], v5, s[16:19], s42 offen offset:256 sc1
    s_xor_b32 s42, s66, 9
    s_lshl_b32 s42, s42, 12
    s_add_u32 s42, s42, s40
    buffer_load_dwordx4 v[200:203], v5, s[16:19], s42 offen sc1
    buffer_load_dwordx4 v[204:207], v5, s[16:19], s42 offen offset:256 sc1
    s_add_u32 m0, s67, 81920
    s_xor_b32 s49, s66, 13
    s_lshl_b32 s49, s49, 17
    s_add_u32 s49, s49, s65
    buffer_load_dwordx4 v3, s[8:11], s49 offen lds
    buffer_load_dwordx4 v4, s[8:11], s49 offen offset:1024 lds
    s_add_u32 m0, s67, 98304
    s_xor_b32 s49, s66, 14
    s_lshl_b32 s49, s49, 17
    s_add_u32 s49, s49, s65
    buffer_load_dwordx4 v3, s[8:11], s49 offen lds
    buffer_load_dwordx4 v4, s[8:11], s49 offen offset:1024 lds
    s_waitcnt vmcnt(12)
    s_nop 0
    v_mfma_f32_16x16x32_bf16 v[128:131], v[64:67], v[240:243], v[128:131]
    ds_read_b64_tr_b16 v[96:97], v28 offset:0
    v_mfma_f32_16x16x32_bf16 v[132:135], v[68:71], v[240:243], v[132:135]
    ds_read_b64_tr_b16 v[98:99], v28 offset:2048
    v_mfma_f32_16x16x32_bf16 v[136:139], v[72:75], v[240:243], v[136:139]
    ds_read_b64_tr_b16 v[100:101], v29 offset:0
    v_mfma_f32_16x16x32_bf16 v[140:143], v[76:79], v[240:243], v[140:143]
    ds_read_b64_tr_b16 v[102:103], v29 offset:2048
    s_waitcnt lgkmcnt(4)
    s_nop 0
    v_mfma_f32_16x16x32_bf16 v[160:163], v[80:83], v[240:243], v[160:163]
    ds_read_b64_tr_b16 v[104:105], v30 offset:0
    v_mfma_f32_16x16x32_bf16 v[164:167], v[84:87], v[240:243], v[164:167]
    ds_read_b64_tr_b16 v[106:107], v30 offset:2048
    v_mfma_f32_16x16x32_bf16 v[168:171], v[88:91], v[240:243], v[168:171]
    ds_read_b64_tr_b16 v[108:109], v31 offset:0
    v_mfma_f32_16x16x32_bf16 v[172:175], v[92:95], v[240:243], v[172:175]
    ds_read_b64_tr_b16 v[110:111], v31 offset:2048
    v_mfma_f32_16x16x32_bf16 v[188:191], v[92:95], v[244:247], v[188:191]
    ds_read_b64_tr_b16 v[112:113], v32 offset:0
    v_mfma_f32_16x16x32_bf16 v[184:187], v[88:91], v[244:247], v[184:187]
    ds_read_b64_tr_b16 v[114:115], v32 offset:2048
    v_mfma_f32_16x16x32_bf16 v[180:183], v[84:87], v[244:247], v[180:183]
    ds_read_b64_tr_b16 v[116:117], v33 offset:0
    v_mfma_f32_16x16x32_bf16 v[176:179], v[80:83], v[244:247], v[176:179]
    ds_read_b64_tr_b16 v[118:119], v33 offset:2048
    v_mfma_f32_16x16x32_bf16 v[156:159], v[76:79], v[244:247], v[156:159]
    ds_read_b64_tr_b16 v[120:121], v34 offset:0
    v_mfma_f32_16x16x32_bf16 v[152:155], v[72:75], v[244:247], v[152:155]
    ds_read_b64_tr_b16 v[122:123], v34 offset:2048
    v_mfma_f32_16x16x32_bf16 v[148:151], v[68:71], v[244:247], v[148:151]
    ds_read_b64_tr_b16 v[124:125], v35 offset:0
    v_mfma_f32_16x16x32_bf16 v[144:147], v[64:67], v[244:247], v[144:147]
    ds_read_b64_tr_b16 v[126:127], v35 offset:2048
    s_waitcnt vmcnt(10) lgkmcnt(8)
    s_nop 0
    v_mfma_f32_16x16x32_bf16 v[128:131], v[96:99], v[248:251], v[128:131]
    ds_read_b64_tr_b16 v[64:65], v6 offset:0
    v_mfma_f32_16x16x32_bf16 v[132:135], v[100:103], v[248:251], v[132:135]
    ds_read_b64_tr_b16 v[66:67], v6 offset:2048
    v_mfma_f32_16x16x32_bf16 v[136:139], v[104:107], v[248:251], v[136:139]
    ds_read_b64_tr_b16 v[68:69], v7 offset:0
    v_mfma_f32_16x16x32_bf16 v[140:143], v[108:111], v[248:251], v[140:143]
    ds_read_b64_tr_b16 v[70:71], v7 offset:2048
    s_waitcnt lgkmcnt(4)
    s_nop 0
    v_mfma_f32_16x16x32_bf16 v[160:163], v[112:115], v[248:251], v[160:163]
    ds_read_b64_tr_b16 v[72:73], v8 offset:0
    v_mfma_f32_16x16x32_bf16 v[164:167], v[116:119], v[248:251], v[164:167]
    ds_read_b64_tr_b16 v[74:75], v8 offset:2048
    v_mfma_f32_16x16x32_bf16 v[168:171], v[120:123], v[248:251], v[168:171]
    ds_read_b64_tr_b16 v[76:77], v9 offset:0
    v_mfma_f32_16x16x32_bf16 v[172:175], v[124:127], v[248:251], v[172:175]
    ds_read_b64_tr_b16 v[78:79], v9 offset:2048
    v_mfma_f32_16x16x32_bf16 v[188:191], v[124:127], v[252:255], v[188:191]
    ds_read_b64_tr_b16 v[80:81], v10 offset:0
    v_mfma_f32_16x16x32_bf16 v[184:187], v[120:123], v[252:255], v[184:187]
    ds_read_b64_tr_b16 v[82:83], v10 offset:2048
    v_mfma_f32_16x16x32_bf16 v[180:183], v[116:119], v[252:255], v[180:183]
    ds_read_b64_tr_b16 v[84:85], v11 offset:0
    v_mfma_f32_16x16x32_bf16 v[176:179], v[112:115], v[252:255], v[176:179]
    ds_read_b64_tr_b16 v[86:87], v11 offset:2048
    v_mfma_f32_16x16x32_bf16 v[156:159], v[108:111], v[252:255], v[156:159]
    ds_read_b64_tr_b16 v[88:89], v12 offset:0
    v_mfma_f32_16x16x32_bf16 v[152:155], v[104:107], v[252:255], v[152:155]
    ds_read_b64_tr_b16 v[90:91], v12 offset:2048
    v_mfma_f32_16x16x32_bf16 v[148:151], v[100:103], v[252:255], v[148:151]
    ds_read_b64_tr_b16 v[92:93], v13 offset:0
    v_mfma_f32_16x16x32_bf16 v[144:147], v[96:99], v[252:255], v[144:147]
    ds_read_b64_tr_b16 v[94:95], v13 offset:2048
    s_waitcnt vmcnt(14) lgkmcnt(8)
    s_barrier
    s_xor_b32 s42, s66, 10
    s_lshl_b32 s42, s42, 12
    s_add_u32 s42, s42, s40
    buffer_load_dwordx4 v[208:211], v5, s[16:19], s42 offen sc1
    buffer_load_dwordx4 v[212:215], v5, s[16:19], s42 offen offset:256 sc1
    s_xor_b32 s42, s66, 11
    s_lshl_b32 s42, s42, 12
    s_add_u32 s42, s42, s40
    buffer_load_dwordx4 v[216:219], v5, s[16:19], s42 offen sc1
    buffer_load_dwordx4 v[220:223], v5, s[16:19], s42 offen offset:256 sc1
    s_add_u32 m0, s67, 114688
    s_xor_b32 s49, s66, 15
    s_lshl_b32 s49, s49, 17
    s_add_u32 s49, s49, s65
    buffer_load_dwordx4 v3, s[8:11], s49 offen lds
    buffer_load_dwordx4 v4, s[8:11], s49 offen offset:1024 lds
    s_waitcnt vmcnt(12)
    v_mfma_f32_16x16x32_bf16 v[128:131], v[64:67], v[192:195], v[128:131]
    ds_read_b64_tr_b16 v[96:97], v6 offset:16384
    v_mfma_f32_16x16x32_bf16 v[132:135], v[68:71], v[192:195], v[132:135]
    ds_read_b64_tr_b16 v[98:99], v6 offset:18432
    v_mfma_f32_16x16x32_bf16 v[136:139], v[72:75], v[192:195], v[136:139]
    ds_read_b64_tr_b16 v[100:101], v7 offset:16384
    v_mfma_f32_16x16x32_bf16 v[140:143], v[76:79], v[192:195], v[140:143]
    ds_read_b64_tr_b16 v[102:103], v7 offset:18432
    s_waitcnt lgkmcnt(4)
    s_nop 0
    v_mfma_f32_16x16x32_bf16 v[160:163], v[80:83], v[192:195], v[160:163]
    ds_read_b64_tr_b16 v[104:105], v8 offset:16384
    v_mfma_f32_16x16x32_bf16 v[164:167], v[84:87], v[192:195], v[164:167]
    ds_read_b64_tr_b16 v[106:107], v8 offset:18432
    v_mfma_f32_16x16x32_bf16 v[168:171], v[88:91], v[192:195], v[168:171]
    ds_read_b64_tr_b16 v[108:109], v9 offset:16384
    v_mfma_f32_16x16x32_bf16 v[172:175], v[92:95], v[192:195], v[172:175]
    ds_read_b64_tr_b16 v[110:111], v9 offset:18432
    v_mfma_f32_16x16x32_bf16 v[188:191], v[92:95], v[196:199], v[188:191]
    ds_read_b64_tr_b16 v[112:113], v10 offset:16384
    v_mfma_f32_16x16x32_bf16 v[184:187], v[88:91], v[196:199], v[184:187]
    ds_read_b64_tr_b16 v[114:115], v10 offset:18432
    v_mfma_f32_16x16x32_bf16 v[180:183], v[84:87], v[196:199], v[180:183]
    ds_read_b64_tr_b16 v[116:117], v11 offset:16384
    v_mfma_f32_16x16x32_bf16 v[176:179], v[80:83], v[196:199], v[176:179]
    ds_read_b64_tr_b16 v[118:119], v11 offset:18432
    v_mfma_f32_16x16x32_bf16 v[156:159], v[76:79], v[196:199], v[156:159]
    ds_read_b64_tr_b16 v[120:121], v12 offset:16384
    v_mfma_f32_16x16x32_bf16 v[152:155], v[72:75], v[196:199], v[152:155]
    ds_read_b64_tr_b16 v[122:123], v12 offset:18432
    v_mfma_f32_16x16x32_bf16 v[148:151], v[68:71], v[196:199], v[148:151]
    ds_read_b64_tr_b16 v[124:125], v13 offset:16384
    v_mfma_f32_16x16x32_bf16 v[144:147], v[64:67], v[196:199], v[144:147]
    ds_read_b64_tr_b16 v[126:127], v13 offset:18432
    s_waitcnt vmcnt(10) lgkmcnt(8)
    s_nop 0
    v_mfma_f32_16x16x32_bf16 v[128:131], v[96:99], v[200:203], v[128:131]
    ds_read_b64_tr_b16 v[64:65], v6 offset:32768
    v_mfma_f32_16x16x32_bf16 v[132:135], v[100:103], v[200:203], v[132:135]
    ds_read_b64_tr_b16 v[66:67], v6 offset:34816
    v_mfma_f32_16x16x32_bf16 v[136:139], v[104:107], v[200:203], v[136:139]
    ds_read_b64_tr_b16 v[68:69], v7 offset:32768
    v_mfma_f32_16x16x32_bf16 v[140:143], v[108:111], v[200:203], v[140:143]
    ds_read_b64_tr_b16 v[70:71], v7 offset:34816
    s_waitcnt lgkmcnt(4)
    s_nop 0
    v_mfma_f32_16x16x32_bf16 v[160:163], v[112:115], v[200:203], v[160:163]
    ds_read_b64_tr_b16 v[72:73], v8 offset:32768
    v_mfma_f32_16x16x32_bf16 v[164:167], v[116:119], v[200:203], v[164:167]
    ds_read_b64_tr_b16 v[74:75], v8 offset:34816
    v_mfma_f32_16x16x32_bf16 v[168:171], v[120:123], v[200:203], v[168:171]
    ds_read_b64_tr_b16 v[76:77], v9 offset:32768
    v_mfma_f32_16x16x32_bf16 v[172:175], v[124:127], v[200:203], v[172:175]
    ds_read_b64_tr_b16 v[78:79], v9 offset:34816
    v_mfma_f32_16x16x32_bf16 v[188:191], v[124:127], v[204:207], v[188:191]
    ds_read_b64_tr_b16 v[80:81], v10 offset:32768
    v_mfma_f32_16x16x32_bf16 v[184:187], v[120:123], v[204:207], v[184:187]
    ds_read_b64_tr_b16 v[82:83], v10 offset:34816
    v_mfma_f32_16x16x32_bf16 v[180:183], v[116:119], v[204:207], v[180:183]
    ds_read_b64_tr_b16 v[84:85], v11 offset:32768
    v_mfma_f32_16x16x32_bf16 v[176:179], v[112:115], v[204:207], v[176:179]
    ds_read_b64_tr_b16 v[86:87], v11 offset:34816
    v_mfma_f32_16x16x32_bf16 v[156:159], v[108:111], v[204:207], v[156:159]
    ds_read_b64_tr_b16 v[88:89], v12 offset:32768
    v_mfma_f32_16x16x32_bf16 v[152:155], v[104:107], v[204:207], v[152:155]
    ds_read_b64_tr_b16 v[90:91], v12 offset:34816
    v_mfma_f32_16x16x32_bf16 v[148:151], v[100:103], v[204:207], v[148:151]
    ds_read_b64_tr_b16 v[92:93], v13 offset:32768
    v_mfma_f32_16x16x32_bf16 v[144:147], v[96:99], v[204:207], v[144:147]
    ds_read_b64_tr_b16 v[94:95], v13 offset:34816
    s_waitcnt vmcnt(8) lgkmcnt(8)
    s_barrier
    s_xor_b32 s42, s66, 12
    s_lshl_b32 s42, s42, 12
    s_add_u32 s42, s42, s40
    buffer_load_dwordx4 v[224:227], v5, s[16:19], s42 offen sc1
    buffer_load_dwordx4 v[228:231], v5, s[16:19], s42 offen offset:256 sc1
    s_xor_b32 s42, s66, 13
    s_lshl_b32 s42, s42, 12
    s_add_u32 s42, s42, s40
    buffer_load_dwordx4 v[232:235], v5, s[16:19], s42 offen sc1
    buffer_load_dwordx4 v[236:239], v5, s[16:19], s42 offen offset:256 sc1
    s_xor_b32 s42, s66, 14
    s_lshl_b32 s42, s42, 12
    s_add_u32 s42, s42, s40
    buffer_load_dwordx4 v[240:243], v5, s[16:19], s42 offen sc1
    buffer_load_dwordx4 v[244:247], v5, s[16:19], s42 offen offset:256 sc1
    s_xor_b32 s42, s66, 15
    s_lshl_b32 s42, s42, 12
    s_add_u32 s42, s42, s40
    buffer_load_dwordx4 v[248:251], v5, s[16:19], s42 offen sc1
    buffer_load_dwordx4 v[252:255], v5, s[16:19], s42 offen offset:256 sc1
    s_waitcnt vmcnt(12)
    s_nop 0
    v_mfma_f32_16x16x32_bf16 v[128:131], v[64:67], v[208:211], v[128:131]
    ds_read_b64_tr_b16 v[96:97], v6 offset:49152
    v_mfma_f32_16x16x32_bf16 v[132:135], v[68:71], v[208:211], v[132:135]
    ds_read_b64_tr_b16 v[98:99], v6 offset:51200
    v_mfma_f32_16x16x32_bf16 v[136:139], v[72:75], v[208:211], v[136:139]
    ds_read_b64_tr_b16 v[100:101], v7 offset:49152
    v_mfma_f32_16x16x32_bf16 v[140:143], v[76:79], v[208:211], v[140:143]
    ds_read_b64_tr_b16 v[102:103], v7 offset:51200
    s_waitcnt lgkmcnt(4)
    s_nop 0
    v_mfma_f32_16x16x32_bf16 v[160:163], v[80:83], v[208:211], v[160:163]
    ds_read_b64_tr_b16 v[104:105], v8 offset:49152
    v_mfma_f32_16x16x32_bf16 v[164:167], v[84:87], v[208:211], v[164:167]
    ds_read_b64_tr_b16 v[106:107], v8 offset:51200
    v_mfma_f32_16x16x32_bf16 v[168:171], v[88:91], v[208:211], v[168:171]
    ds_read_b64_tr_b16 v[108:109], v9 offset:49152
    v_mfma_f32_16x16x32_bf16 v[172:175], v[92:95], v[208:211], v[172:175]
    ds_read_b64_tr_b16 v[110:111], v9 offset:51200
    v_mfma_f32_16x16x32_bf16 v[188:191], v[92:95], v[212:215], v[188:191]
    ds_read_b64_tr_b16 v[112:113], v10 offset:49152
    v_mfma_f32_16x16x32_bf16 v[184:187], v[88:91], v[212:215], v[184:187]
    ds_read_b64_tr_b16 v[114:115], v10 offset:51200
    v_mfma_f32_16x16x32_bf16 v[180:183], v[84:87], v[212:215], v[180:183]
    ds_read_b64_tr_b16 v[116:117], v11 offset:49152
    v_mfma_f32_16x16x32_bf16 v[176:179], v[80:83], v[212:215], v[176:179]
    ds_read_b64_tr_b16 v[118:119], v11 offset:51200
    v_mfma_f32_16x16x32_bf16 v[156:159], v[76:79], v[212:215], v[156:159]
    ds_read_b64_tr_b16 v[120:121], v12 offset:49152
    v_mfma_f32_16x16x32_bf16 v[152:155], v[72:75], v[212:215], v[152:155]
    ds_read_b64_tr_b16 v[122:123], v12 offset:51200
    v_mfma_f32_16x16x32_bf16 v[148:151], v[68:71], v[212:215], v[148:151]
    ds_read_b64_tr_b16 v[124:125], v13 offset:49152
    v_mfma_f32_16x16x32_bf16 v[144:147], v[64:67], v[212:215], v[144:147]
    ds_read_b64_tr_b16 v[126:127], v13 offset:51200
    s_waitcnt vmcnt(10) lgkmcnt(8)
    s_nop 0
    v_mfma_f32_16x16x32_bf16 v[128:131], v[96:99], v[216:219], v[128:131]
    ds_read_b64_tr_b16 v[64:65], v24 offset:0
    v_mfma_f32_16x16x32_bf16 v[132:135], v[100:103], v[216:219], v[132:135]
    ds_read_b64_tr_b16 v[66:67], v24 offset:2048
    v_mfma_f32_16x16x32_bf16 v[136:139], v[104:107], v[216:219], v[136:139]
    ds_read_b64_tr_b16 v[68:69], v25 offset:0
    v_mfma_f32_16x16x32_bf16 v[140:143], v[108:111], v[216:219], v[140:143]
    ds_read_b64_tr_b16 v[70:71], v25 offset:2048
    s_waitcnt lgkmcnt(4)
    s_nop 0
    v_mfma_f32_16x16x32_bf16 v[160:163], v[112:115], v[216:219], v[160:163]
    ds_read_b64_tr_b16 v[72:73], v26 offset:0
    v_mfma_f32_16x16x32_bf16 v[164:167], v[116:119], v[216:219], v[164:167]
    ds_read_b64_tr_b16 v[74:75], v26 offset:2048
    v_mfma_f32_16x16x32_bf16 v[168:171], v[120:123], v[216:219], v[168:171]
    ds_read_b64_tr_b16 v[76:77], v27 offset:0
    v_mfma_f32_16x16x32_bf16 v[172:175], v[124:127], v[216:219], v[172:175]
    ds_read_b64_tr_b16 v[78:79], v27 offset:2048
    v_mfma_f32_16x16x32_bf16 v[188:191], v[124:127], v[220:223], v[188:191]
    ds_read_b64_tr_b16 v[80:81], v24 offset:16384
    v_mfma_f32_16x16x32_bf16 v[184:187], v[120:123], v[220:223], v[184:187]
    ds_read_b64_tr_b16 v[82:83], v24 offset:18432
    v_mfma_f32_16x16x32_bf16 v[180:183], v[116:119], v[220:223], v[180:183]
    ds_read_b64_tr_b16 v[84:85], v25 offset:16384
    v_mfma_f32_16x16x32_bf16 v[176:179], v[112:115], v[220:223], v[176:179]
    ds_read_b64_tr_b16 v[86:87], v25 offset:18432
    v_mfma_f32_16x16x32_bf16 v[156:159], v[108:111], v[220:223], v[156:159]
    ds_read_b64_tr_b16 v[88:89], v26 offset:16384
    v_mfma_f32_16x16x32_bf16 v[152:155], v[104:107], v[220:223], v[152:155]
    ds_read_b64_tr_b16 v[90:91], v26 offset:18432
    v_mfma_f32_16x16x32_bf16 v[148:151], v[100:103], v[220:223], v[148:151]
    ds_read_b64_tr_b16 v[92:93], v27 offset:16384
    v_mfma_f32_16x16x32_bf16 v[144:147], v[96:99], v[220:223], v[144:147]
    ds_read_b64_tr_b16 v[94:95], v27 offset:18432
    s_branch G3JOIN_105
.p2align 12
G3JOIN_105:
    s_waitcnt vmcnt(0) lgkmcnt(8)
    s_barrier
    v_mfma_f32_16x16x32_bf16 v[160:163], v[64:67], v[224:227], v[160:163]
    ds_read_b64_tr_b16 v[96:97], v24 offset:32768
    v_mfma_f32_16x16x32_bf16 v[164:167], v[68:71], v[224:227], v[164:167]
    ds_read_b64_tr_b16 v[98:99], v24 offset:34816
    v_mfma_f32_16x16x32_bf16 v[168:171], v[72:75], v[224:227], v[168:171]
    ds_read_b64_tr_b16 v[100:101], v25 offset:32768
    v_mfma_f32_16x16x32_bf16 v[172:175], v[76:79], v[224:227], v[172:175]
    ds_read_b64_tr_b16 v[102:103], v25 offset:34816
    s_waitcnt lgkmcnt(4)
    s_nop 0
    v_mfma_f32_16x16x32_bf16 v[160:163], v[80:83], v[232:235], v[160:163]
    ds_read_b64_tr_b16 v[104:105], v26 offset:32768
    v_mfma_f32_16x16x32_bf16 v[164:167], v[84:87], v[232:235], v[164:167]
    ds_read_b64_tr_b16 v[106:107], v26 offset:34816
    v_mfma_f32_16x16x32_bf16 v[168:171], v[88:91], v[232:235], v[168:171]
    ds_read_b64_tr_b16 v[108:109], v27 offset:32768
    v_mfma_f32_16x16x32_bf16 v[172:175], v[92:95], v[232:235], v[172:175]
    ds_read_b64_tr_b16 v[110:111], v27 offset:34816
    v_mfma_f32_16x16x32_bf16 v[188:191], v[92:95], v[236:239], v[188:191]
    ds_read_b64_tr_b16 v[112:113], v24 offset:49152
    v_mfma_f32_16x16x32_bf16 v[184:187], v[88:91], v[236:239], v[184:187]
    ds_read_b64_tr_b16 v[114:115], v24 offset:51200
    v_mfma_f32_16x16x32_bf16 v[180:183], v[84:87], v[236:239], v[180:183]
    ds_read_b64_tr_b16 v[116:117], v25 offset:49152
    v_mfma_f32_16x16x32_bf16 v[176:179], v[80:83], v[236:239], v[176:179]
    ds_read_b64_tr_b16 v[118:119], v25 offset:51200
    v_mfma_f32_16x16x32_bf16 v[188:191], v[76:79], v[228:231], v[188:191]
    ds_read_b64_tr_b16 v[120:121], v26 offset:49152
    v_mfma_f32_16x16x32_bf16 v[184:187], v[72:75], v[228:231], v[184:187]
    ds_read_b64_tr_b16 v[122:123], v26 offset:51200
    v_mfma_f32_16x16x32_bf16 v[180:183], v[68:71], v[228:231], v[180:183]
    ds_read_b64_tr_b16 v[124:125], v27 offset:49152
    v_mfma_f32_16x16x32_bf16 v[176:179], v[64:67], v[228:231], v[176:179]
    ds_read_b64_tr_b16 v[126:127], v27 offset:51200
    s_waitcnt vmcnt(63) lgkmcnt(8)
    s_nop 0
    v_mfma_f32_16x16x32_bf16 v[160:163], v[96:99], v[240:243], v[160:163]
    ds_read_b64_tr_b16 v[64:65], v20 offset:0
    v_mfma_f32_16x16x32_bf16 v[164:167], v[100:103], v[240:243], v[164:167]
    ds_read_b64_tr_b16 v[66:67], v20 offset:2048
    v_mfma_f32_16x16x32_bf16 v[168:171], v[104:107], v[240:243], v[168:171]
    ds_read_b64_tr_b16 v[68:69], v21 offset:0
    v_mfma_f32_16x16x32_bf16 v[172:175], v[108:111], v[240:243], v[172:175]
    ds_read_b64_tr_b16 v[70:71], v21 offset:2048
    s_waitcnt lgkmcnt(4)
    s_nop 0
    v_mfma_f32_16x16x32_bf16 v[160:163], v[112:115], v[248:251], v[160:163]
    ds_read_b64_tr_b16 v[72:73], v22 offset:0
    v_mfma_f32_16x16x32_bf16 v[164:167], v[116:119], v[248:251], v[164:167]
    ds_read_b64_tr_b16 v[74:75], v22 offset:2048
    v_mfma_f32_16x16x32_bf16 v[168:171], v[120:123], v[248:251], v[168:171]
    ds_read_b64_tr_b16 v[76:77], v23 offset:0
    v_mfma_f32_16x16x32_bf16 v[172:175], v[124:127], v[248:251], v[172:175]
    ds_read_b64_tr_b16 v[78:79], v23 offset:2048
    v_mfma_f32_16x16x32_bf16 v[188:191], v[124:127], v[252:255], v[188:191]
    ds_read_b64_tr_b16 v[80:81], v20 offset:16384
    v_mfma_f32_16x16x32_bf16 v[184:187], v[120:123], v[252:255], v[184:187]
    ds_read_b64_tr_b16 v[82:83], v20 offset:18432
    v_mfma_f32_16x16x32_bf16 v[180:183], v[116:119], v[252:255], v[180:183]
    ds_read_b64_tr_b16 v[84:85], v21 offset:16384
    v_mfma_f32_16x16x32_bf16 v[176:179], v[112:115], v[252:255], v[176:179]
    ds_read_b64_tr_b16 v[86:87], v21 offset:18432
    v_mfma_f32_16x16x32_bf16 v[188:191], v[108:111], v[244:247], v[188:191]
    ds_read_b64_tr_b16 v[88:89], v22 offset:16384
    v_mfma_f32_16x16x32_bf16 v[184:187], v[104:107], v[244:247], v[184:187]
    ds_read_b64_tr_b16 v[90:91], v22 offset:18432
    v_mfma_f32_16x16x32_bf16 v[180:183], v[100:103], v[244:247], v[180:183]
    ds_read_b64_tr_b16 v[92:93], v23 offset:16384
    v_mfma_f32_16x16x32_bf16 v[176:179], v[96:99], v[244:247], v[176:179]
    ds_read_b64_tr_b16 v[94:95], v23 offset:18432
    s_waitcnt vmcnt(63) lgkmcnt(8)
    s_nop 0
    v_mfma_f32_16x16x32_bf16 v[128:131], v[64:67], v[224:227], v[128:131]
    ds_read_b64_tr_b16 v[96:97], v20 offset:32768
    v_mfma_f32_16x16x32_bf16 v[132:135], v[68:71], v[224:227], v[132:135]
    ds_read_b64_tr_b16 v[98:99], v20 offset:34816
    v_mfma_f32_16x16x32_bf16 v[136:139], v[72:75], v[224:227], v[136:139]
    ds_read_b64_tr_b16 v[100:101], v21 offset:32768
    v_mfma_f32_16x16x32_bf16 v[140:143], v[76:79], v[224:227], v[140:143]
    ds_read_b64_tr_b16 v[102:103], v21 offset:34816
    s_waitcnt lgkmcnt(4)
    s_nop 0
    v_mfma_f32_16x16x32_bf16 v[128:131], v[80:83], v[232:235], v[128:131]
    ds_read_b64_tr_b16 v[104:105], v22 offset:32768
    ds_write_b128 v36, v[160:163] offset:0
    v_mfma_f32_16x16x32_bf16 v[132:135], v[84:87], v[232:235], v[132:135]
    ds_read_b64_tr_b16 v[106:107], v22 offset:34816
    ds_write_b128 v36, v[164:167] offset:1024
    v_mfma_f32_16x16x32_bf16 v[136:139], v[88:91], v[232:235], v[136:139]
    ds_read_b64_tr_b16 v[108:109], v23 offset:32768
    ds_write_b128 v36, v[168:171] offset:2048
    v_mfma_f32_16x16x32_bf16 v[140:143], v[92:95], v[232:235], v[140:143]
    ds_read_b64_tr_b16 v[110:111], v23 offset:34816
    ds_write_b128 v36, v[172:175] offset:3072
    v_mfma_f32_16x16x32_bf16 v[156:159], v[92:95], v[236:239], v[156:159]
    ds_read_b64_tr_b16 v[112:113], v20 offset:49152
    ds_write_b128 v36, v[176:179] offset:4096
    v_mfma_f32_16x16x32_bf16 v[152:155], v[88:91], v[236:239], v[152:155]
    ds_read_b64_tr_b16 v[114:115], v20 offset:51200
    ds_write_b128 v36, v[180:183] offset:5120
    v_mfma_f32_16x16x32_bf16 v[148:151], v[84:87], v[236:239], v[148:151]
    ds_read_b64_tr_b16 v[116:117], v21 offset:49152
    ds_write_b128 v36, v[184:187] offset:6144
    v_mfma_f32_16x16x32_bf16 v[144:147], v[80:83], v[236:239], v[144:147]
    ds_read_b64_tr_b16 v[118:119], v21 offset:51200
    ds_write_b128 v36, v[188:191] offset:7168
    v_mfma_f32_16x16x32_bf16 v[156:159], v[76:79], v[228:231], v[156:159]
    ds_read_b64_tr_b16 v[120:121], v22 offset:49152
    v_mfma_f32_16x16x32_bf16 v[152:155], v[72:75], v[228:231], v[152:155]
    ds_read_b64_tr_b16 v[122:123], v22 offset:51200
    v_mfma_f32_16x16x32_bf16 v[148:151], v[68:71], v[228:231], v[148:151]
    ds_read_b64_tr_b16 v[124:125], v23 offset:49152
    v_mfma_f32_16x16x32_bf16 v[144:147], v[64:67], v[228:231], v[144:147]
    ds_read_b64_tr_b16 v[126:127], v23 offset:51200
    s_waitcnt vmcnt(63) lgkmcnt(0)
    s_barrier
    v_mfma_f32_16x16x32_bf16 v[128:131], v[96:99], v[240:243], v[128:131]
    ds_read_b128 v[64:67], v37 offset:0
    v_mfma_f32_16x16x32_bf16 v[132:135], v[100:103], v[240:243], v[132:135]
    ds_read_b128 v[68:71], v37 offset:1024
    v_mfma_f32_16x16x32_bf16 v[136:139], v[104:107], v[240:243], v[136:139]
    ds_read_b128 v[72:75], v37 offset:2048
    v_mfma_f32_16x16x32_bf16 v[140:143], v[108:111], v[240:243], v[140:143]
    ds_read_b128 v[76:79], v37 offset:3072
    v_mfma_f32_16x16x32_bf16 v[128:131], v[112:115], v[248:251], v[128:131]
    ds_read_b128 v[80:83], v37 offset:4096
    v_mfma_f32_16x16x32_bf16 v[132:135], v[116:119], v[248:251], v[132:135]
    ds_read_b128 v[84:87], v37 offset:5120
    v_mfma_f32_16x16x32_bf16 v[136:139], v[120:123], v[248:251], v[136:139]
    ds_read_b128 v[88:91], v37 offset:6144
    v_mfma_f32_16x16x32_bf16 v[140:143], v[124:127], v[248:251], v[140:143]
    ds_read_b128 v[92:95], v37 offset:7168
    v_mfma_f32_16x16x32_bf16 v[156:159], v[124:127], v[252:255], v[156:159]
    v_mfma_f32_16x16x32_bf16 v[152:155], v[120:123], v[252:255], v[152:155]
    v_mfma_f32_16x16x32_bf16 v[148:151], v[116:119], v[252:255], v[148:151]
    v_mfma_f32_16x16x32_bf16 v[144:147], v[112:115], v[252:255], v[144:147]
    v_mfma_f32_16x16x32_bf16 v[156:159], v[108:111], v[244:247], v[156:159]
    v_mfma_f32_16x16x32_bf16 v[152:155], v[104:107], v[244:247], v[152:155]
    v_mfma_f32_16x16x32_bf16 v[148:151], v[100:103], v[244:247], v[148:151]
    v_mfma_f32_16x16x32_bf16 v[144:147], v[96:99], v[244:247], v[144:147]
    s_waitcnt lgkmcnt(0)
    s_nop 0
    v_pk_add_f32 v[128:129], v[128:129], v[64:65]
    v_pk_add_f32 v[130:131], v[130:131], v[66:67]
    v_pk_add_f32 v[132:133], v[132:133], v[68:69]
    v_pk_add_f32 v[134:135], v[134:135], v[70:71]
    v_cvt_pk_bf16_f32 v160, v128, v129
    v_cvt_pk_bf16_f32 v161, v130, v131
    v_cvt_pk_bf16_f32 v162, v132, v133
    v_cvt_pk_bf16_f32 v163, v134, v135
    s_nop 1
    v_permlane16_swap_b32 v160, v162
    v_permlane16_swap_b32_e64 v161, v163
    buffer_store_dwordx4 v[160:163], v38, s[12:15], s54 offen offset:0 nt
    v_pk_add_f32 v[136:137], v[136:137], v[72:73]
    v_pk_add_f32 v[138:139], v[138:139], v[74:75]
    v_pk_add_f32 v[140:141], v[140:141], v[76:77]
    v_pk_add_f32 v[142:143], v[142:143], v[78:79]
    v_cvt_pk_bf16_f32 v164, v136, v137
    v_cvt_pk_bf16_f32 v165, v138, v139
    v_cvt_pk_bf16_f32 v166, v140, v141
    v_cvt_pk_bf16_f32 v167, v142, v143
    s_nop 1
    v_permlane16_swap_b32 v164, v166
    v_permlane16_swap_b32_e64 v165, v167
    buffer_store_dwordx4 v[164:167], v38, s[12:15], s54 offen offset:64 nt
    v_pk_add_f32 v[144:145], v[144:145], v[80:81]
    v_pk_add_f32 v[146:147], v[146:147], v[82:83]
    v_pk_add_f32 v[148:149], v[148:149], v[84:85]
    v_pk_add_f32 v[150:151], v[150:151], v[86:87]
    v_cvt_pk_bf16_f32 v168, v144, v145
    v_cvt_pk_bf16_f32 v169, v146, v147
    v_cvt_pk_bf16_f32 v170, v148, v149
    v_cvt_pk_bf16_f32 v171, v150, v151
    s_nop 1
    v_permlane16_swap_b32 v168, v170
    v_permlane16_swap_b32_e64 v169, v171
    buffer_store_dwordx4 v[168:171], v38, s[12:15], s55 offen offset:0 nt
    v_pk_add_f32 v[152:153], v[152:153], v[88:89]
    v_pk_add_f32 v[154:155], v[154:155], v[90:91]
    v_pk_add_f32 v[156:157], v[156:157], v[92:93]
    v_pk_add_f32 v[158:159], v[158:159], v[94:95]
    v_cvt_pk_bf16_f32 v172, v152, v153
    v_cvt_pk_bf16_f32 v173, v154, v155
    v_cvt_pk_bf16_f32 v174, v156, v157
    v_cvt_pk_bf16_f32 v175, v158, v159
    s_nop 1
    v_permlane16_swap_b32 v172, v174
    v_permlane16_swap_b32_e64 v173, v175
    buffer_store_dwordx4 v[172:175], v38, s[12:15], s55 offen offset:64 nt
END_1:
    s_endpgm
DRA_80:
    s_waitcnt vmcnt(0)
    s_branch DRR_81
PUBA_78:
    s_cmp_lg_u32 s6, 0
    s_cbranch_scc1 NF_107
    v_mov_b32 v14, 0
    v_mov_b32 v15, 1
    s_mov_b64 exec, 1
    buffer_store_dword v15, v14, s[16:19], s60 offen sc1
    s_mov_b64 exec, -1
NF_107:
    s_branch PUBR_79
FSLOW_65:
    v_mfma_f32_32x32x16_bf16 v[64:79], v[176:179], v[144:147], 0
    v_mfma_f32_32x32x16_bf16 v[64:79], v[180:183], v[148:151], v[64:79]
    s_nop 15
    s_nop 0
    v_max3_f32 v14, v64, v65, v66
    v_min3_f32 v16, v64, v65, v66
    v_max3_f32 v14, v14, v67, v68
    v_min3_f32 v16, v16, v67, v68
    v_max3_f32 v14, v14, v69, v70
    v_min3_f32 v16, v16, v69, v70
    v_max3_f32 v14, v14, v71, v72
    v_min3_f32 v16, v16, v71, v72
    v_max3_f32 v14, v14, v73, v74
    v_min3_f32 v16, v16, v73, v74
    v_max3_f32 v14, v14, v75, v76
    v_min3_f32 v16, v16, v75, v76
    v_max3_f32 v14, v14, v77, v78
    v_min3_f32 v16, v16, v77, v78
    v_max_f32 v14, v14, v79
    v_min_f32 v16, v16, v79
    v_mov_b32 v18, v14
    v_mov_b32 v19, v16
    s_nop 1
    v_permlane32_swap_b32 v14, v18
    v_permlane32_swap_b32 v16, v19
    s_nop 0
    v_max_f32 v14, v14, v18
    v_min_f32 v16, v16, v19
    v_mul_f32 v14, s24, v14
    v_mul_f32 v16, s24, v16
    v_pk_fma_f32 v[48:49], v[64:65], s[24:25], v[16:17] op_sel_hi:[1,1,0] neg_lo:[1,0,0] neg_hi:[1,0,0]
    v_pk_fma_f32 v[64:65], v[64:65], s[24:25], v[14:15] op_sel_hi:[1,1,0] neg_lo:[0,0,1] neg_hi:[0,0,1]
    v_pk_fma_f32 v[50:51], v[66:67], s[24:25], v[16:17] op_sel_hi:[1,1,0] neg_lo:[1,0,0] neg_hi:[1,0,0]
    v_pk_fma_f32 v[66:67], v[66:67], s[24:25], v[14:15] op_sel_hi:[1,1,0] neg_lo:[0,0,1] neg_hi:[0,0,1]
    v_pk_fma_f32 v[52:53], v[68:69], s[24:25], v[16:17] op_sel_hi:[1,1,0] neg_lo:[1,0,0] neg_hi:[1,0,0]
    v_pk_fma_f32 v[68:69], v[68:69], s[24:25], v[14:15] op_sel_hi:[1,1,0] neg_lo:[0,0,1] neg_hi:[0,0,1]
    v_pk_fma_f32 v[54:55], v[70:71], s[24:25], v[16:17] op_sel_hi:[1,1,0] neg_lo:[1,0,0] neg_hi:[1,0,0]
    v_pk_fma_f32 v[70:71], v[70:71], s[24:25], v[14:15] op_sel_hi:[1,1,0] neg_lo:[0,0,1] neg_hi:[0,0,1]
    v_pk_fma_f32 v[56:57], v[72:73], s[24:25], v[16:17] op_sel_hi:[1,1,0] neg_lo:[1,0,0] neg_hi:[1,0,0]
    v_pk_fma_f32 v[72:73], v[72:73], s[24:25], v[14:15] op_sel_hi:[1,1,0] neg_lo:[0,0,1] neg_hi:[0,0,1]
    v_pk_fma_f32 v[58:59], v[74:75], s[24:25], v[16:17] op_sel_hi:[1,1,0] neg_lo:[1,0,0] neg_hi:[1,0,0]
    v_pk_fma_f32 v[74:75], v[74:75], s[24:25], v[14:15] op_sel_hi:[1,1,0] neg_lo:[0,0,1] neg_hi:[0,0,1]
    v_pk_fma_f32 v[60:61], v[76:77], s[24:25], v[16:17] op_sel_hi:[1,1,0] neg_lo:[1,0,0] neg_hi:[1,0,0]
    v_pk_fma_f32 v[76:77], v[76:77], s[24:25], v[14:15] op_sel_hi:[1,1,0] neg_lo:[0,0,1] neg_hi:[0,0,1]
    v_pk_fma_f32 v[62:63], v[78:79], s[24:25], v[16:17] op_sel_hi:[1,1,0] neg_lo:[1,0,0] neg_hi:[1,0,0]
    v_pk_fma_f32 v[78:79], v[78:79], s[24:25], v[14:15] op_sel_hi:[1,1,0] neg_lo:[0,0,1] neg_hi:[0,0,1]
    v_exp_f32 v48, v48
    v_exp_f32 v64, v64
    v_exp_f32 v49, v49
    v_exp_f32 v65, v65
    v_exp_f32 v50, v50
    v_exp_f32 v66, v66
    v_exp_f32 v51, v51
    v_exp_f32 v67, v67
    v_exp_f32 v52, v52
    v_exp_f32 v68, v68
    v_exp_f32 v53, v53
    v_exp_f32 v69, v69
    v_exp_f32 v54, v54
    v_exp_f32 v70, v70
    v_exp_f32 v55, v55
    v_exp_f32 v71, v71
    v_exp_f32 v56, v56
    v_exp_f32 v72, v72
    v_exp_f32 v57, v57
    v_exp_f32 v73, v73
    v_exp_f32 v58, v58
    v_exp_f32 v74, v74
    v_exp_f32 v59, v59
    v_exp_f32 v75, v75
    v_exp_f32 v60, v60
    v_exp_f32 v76, v76
    v_exp_f32 v61, v61
    v_exp_f32 v77, v77
    v_exp_f32 v62, v62
    v_exp_f32 v78, v78
    v_exp_f32 v63, v63
    v_exp_f32 v79, v79
    v_pk_add_f32 v[22:23], v[48:49], v[50:51]
    v_pk_add_f32 v[18:19], v[64:65], v[66:67]
    v_pk_add_f32 v[22:23], v[22:23], v[52:53]
    v_pk_add_f32 v[18:19], v[18:19], v[68:69]
    v_pk_add_f32 v[22:23], v[22:23], v[54:55]
    v_pk_add_f32 v[18:19], v[18:19], v[70:71]
    v_pk_add_f32 v[22:23], v[22:23], v[56:57]
    v_pk_add_f32 v[18:19], v[18:19], v[72:73]
    v_pk_add_f32 v[22:23], v[22:23], v[58:59]
    v_pk_add_f32 v[18:19], v[18:19], v[74:75]
    v_pk_add_f32 v[22:23], v[22:23], v[60:61]
    v_pk_add_f32 v[18:19], v[18:19], v[76:77]
    v_pk_add_f32 v[22:23], v[22:23], v[62:63]
    v_pk_add_f32 v[18:19], v[18:19], v[78:79]
    v_add_f32 v22, v22, v23
    v_add_f32 v18, v18, v19
    v_mov_b32 v24, v22
    v_mov_b32 v20, v18
    s_nop 1
    v_permlane32_swap_b32 v22, v24
    v_permlane32_swap_b32 v18, v20
    s_nop 0
    v_add_f32 v22, v22, v24
    v_add_f32 v18, v18, v20
    v_rcp_f32_e64 v22, v22
    v_rcp_f32 v18, v18
    s_nop 0
    v_pk_mul_f32 v[48:49], v[48:49], v[22:23] op_sel_hi:[1,0]
    v_pk_mul_f32 v[64:65], v[64:65], v[18:19] op_sel_hi:[1,0]
    v_pk_mul_f32 v[50:51], v[50:51], v[22:23] op_sel_hi:[1,0]
    v_pk_mul_f32 v[66:67], v[66:67], v[18:19] op_sel_hi:[1,0]
    v_pk_mul_f32 v[52:53], v[52:53], v[22:23] op_sel_hi:[1,0]
    v_pk_mul_f32 v[68:69], v[68:69], v[18:19] op_sel_hi:[1,0]
    v_pk_mul_f32 v[54:55], v[54:55], v[22:23] op_sel_hi:[1,0]
    v_pk_mul_f32 v[70:71], v[70:71], v[18:19] op_sel_hi:[1,0]
    v_pk_mul_f32 v[56:57], v[56:57], v[22:23] op_sel_hi:[1,0]
    v_pk_mul_f32 v[72:73], v[72:73], v[18:19] op_sel_hi:[1,0]
    v_pk_mul_f32 v[58:59], v[58:59], v[22:23] op_sel_hi:[1,0]
    v_pk_mul_f32 v[74:75], v[74:75], v[18:19] op_sel_hi:[1,0]
    v_pk_mul_f32 v[60:61], v[60:61], v[22:23] op_sel_hi:[1,0]
    v_pk_mul_f32 v[76:77], v[76:77], v[18:19] op_sel_hi:[1,0]
    v_pk_mul_f32 v[62:63], v[62:63], v[22:23] op_sel_hi:[1,0]
    v_pk_mul_f32 v[78:79], v[78:79], v[18:19] op_sel_hi:[1,0]
    v_cvt_pk_bf16_f32 v80, v48, v49
    v_cvt_pk_bf16_f32 v144, v64, v65
    v_cvt_pk_bf16_f32 v81, v50, v51
    v_cvt_pk_bf16_f32 v145, v66, v67
    v_cvt_pk_bf16_f32 v82, v52, v53
    v_cvt_pk_bf16_f32 v146, v68, v69
    v_cvt_pk_bf16_f32 v83, v54, v55
    v_cvt_pk_bf16_f32 v147, v70, v71
    v_cvt_pk_bf16_f32 v84, v56, v57
    v_cvt_pk_bf16_f32 v148, v72, v73
    v_cvt_pk_bf16_f32 v85, v58, v59
    v_cvt_pk_bf16_f32 v149, v74, v75
    v_cvt_pk_bf16_f32 v86, v60, v61
    v_cvt_pk_bf16_f32 v150, v76, v77
    v_cvt_pk_bf16_f32 v87, v62, v63
    v_cvt_pk_bf16_f32 v151, v78, v79
    s_branch FBACK_66
FSLOW_67:
    v_mfma_f32_32x32x16_bf16 v[112:127], v[176:179], v[152:155], 0
    v_mfma_f32_32x32x16_bf16 v[112:127], v[180:183], v[156:159], v[112:127]
    s_nop 15
    v_max3_f32 v14, v112, v113, v114
    v_min3_f32 v16, v112, v113, v114
    v_max3_f32 v14, v14, v115, v116
    v_min3_f32 v16, v16, v115, v116
    v_max3_f32 v14, v14, v117, v118
    v_min3_f32 v16, v16, v117, v118
    v_max3_f32 v14, v14, v119, v120
    v_min3_f32 v16, v16, v119, v120
    v_max3_f32 v14, v14, v121, v122
    v_min3_f32 v16, v16, v121, v122
    v_max3_f32 v14, v14, v123, v124
    v_min3_f32 v16, v16, v123, v124
    v_max3_f32 v14, v14, v125, v126
    v_min3_f32 v16, v16, v125, v126
    v_max_f32 v14, v14, v127
    v_min_f32 v16, v16, v127
    v_mov_b32 v18, v14
    v_mov_b32 v19, v16
    s_nop 1
    v_permlane32_swap_b32 v14, v18
    v_permlane32_swap_b32 v16, v19
    s_nop 0
    v_max_f32 v14, v14, v18
    v_min_f32 v16, v16, v19
    v_mul_f32 v14, s24, v14
    v_mul_f32 v16, s24, v16
    v_pk_fma_f32 v[96:97], v[112:113], s[24:25], v[16:17] op_sel_hi:[1,1,0] neg_lo:[1,0,0] neg_hi:[1,0,0]
    v_pk_fma_f32 v[112:113], v[112:113], s[24:25], v[14:15] op_sel_hi:[1,1,0] neg_lo:[0,0,1] neg_hi:[0,0,1]
    v_pk_fma_f32 v[98:99], v[114:115], s[24:25], v[16:17] op_sel_hi:[1,1,0] neg_lo:[1,0,0] neg_hi:[1,0,0]
    v_pk_fma_f32 v[114:115], v[114:115], s[24:25], v[14:15] op_sel_hi:[1,1,0] neg_lo:[0,0,1] neg_hi:[0,0,1]
    v_pk_fma_f32 v[100:101], v[116:117], s[24:25], v[16:17] op_sel_hi:[1,1,0] neg_lo:[1,0,0] neg_hi:[1,0,0]
    v_pk_fma_f32 v[116:117], v[116:117], s[24:25], v[14:15] op_sel_hi:[1,1,0] neg_lo:[0,0,1] neg_hi:[0,0,1]
    v_pk_fma_f32 v[102:103], v[118:119], s[24:25], v[16:17] op_sel_hi:[1,1,0] neg_lo:[1,0,0] neg_hi:[1,0,0]
    v_pk_fma_f32 v[118:119], v[118:119], s[24:25], v[14:15] op_sel_hi:[1,1,0] neg_lo:[0,0,1] neg_hi:[0,0,1]
    v_pk_fma_f32 v[104:105], v[120:121], s[24:25], v[16:17] op_sel_hi:[1,1,0] neg_lo:[1,0,0] neg_hi:[1,0,0]
    v_pk_fma_f32 v[120:121], v[120:121], s[24:25], v[14:15] op_sel_hi:[1,1,0] neg_lo:[0,0,1] neg_hi:[0,0,1]
    v_pk_fma_f32 v[106:107], v[122:123], s[24:25], v[16:17] op_sel_hi:[1,1,0] neg_lo:[1,0,0] neg_hi:[1,0,0]
    v_pk_fma_f32 v[122:123], v[122:123], s[24:25], v[14:15] op_sel_hi:[1,1,0] neg_lo:[0,0,1] neg_hi:[0,0,1]
    v_pk_fma_f32 v[108:109], v[124:125], s[24:25], v[16:17] op_sel_hi:[1,1,0] neg_lo:[1,0,0] neg_hi:[1,0,0]
    v_pk_fma_f32 v[124:125], v[124:125], s[24:25], v[14:15] op_sel_hi:[1,1,0] neg_lo:[0,0,1] neg_hi:[0,0,1]
    v_pk_fma_f32 v[110:111], v[126:127], s[24:25], v[16:17] op_sel_hi:[1,1,0] neg_lo:[1,0,0] neg_hi:[1,0,0]
    v_pk_fma_f32 v[126:127], v[126:127], s[24:25], v[14:15] op_sel_hi:[1,1,0] neg_lo:[0,0,1] neg_hi:[0,0,1]
    v_exp_f32 v96, v96
    v_exp_f32 v112, v112
    v_exp_f32 v97, v97
    v_exp_f32 v113, v113
    v_exp_f32 v98, v98
    v_exp_f32 v114, v114
    v_exp_f32 v99, v99
    v_exp_f32 v115, v115
    v_exp_f32 v100, v100
    v_exp_f32 v116, v116
    v_exp_f32 v101, v101
    v_exp_f32 v117, v117
    v_exp_f32 v102, v102
    v_exp_f32 v118, v118
    v_exp_f32 v103, v103
    v_exp_f32 v119, v119
    v_exp_f32 v104, v104
    v_exp_f32 v120, v120
    v_exp_f32 v105, v105
    v_exp_f32 v121, v121
    v_exp_f32 v106, v106
    v_exp_f32 v122, v122
    v_exp_f32 v107, v107
    v_exp_f32 v123, v123
    v_exp_f32 v108, v108
    v_exp_f32 v124, v124
    v_exp_f32 v109, v109
    v_exp_f32 v125, v125
    v_exp_f32 v110, v110
    v_exp_f32 v126, v126
    v_exp_f32 v111, v111
    v_exp_f32 v127, v127
    v_pk_add_f32 v[22:23], v[96:97], v[98:99]
    v_pk_add_f32 v[18:19], v[112:113], v[114:115]
    v_pk_add_f32 v[22:23], v[22:23], v[100:101]
    v_pk_add_f32 v[18:19], v[18:19], v[116:117]
    v_pk_add_f32 v[22:23], v[22:23], v[102:103]
    v_pk_add_f32 v[18:19], v[18:19], v[118:119]
    v_pk_add_f32 v[22:23], v[22:23], v[104:105]
    v_pk_add_f32 v[18:19], v[18:19], v[120:121]
    v_pk_add_f32 v[22:23], v[22:23], v[106:107]
    v_pk_add_f32 v[18:19], v[18:19], v[122:123]
    v_pk_add_f32 v[22:23], v[22:23], v[108:109]
    v_pk_add_f32 v[18:19], v[18:19], v[124:125]
    v_pk_add_f32 v[22:23], v[22:23], v[110:111]
    v_pk_add_f32 v[18:19], v[18:19], v[126:127]
    v_add_f32 v22, v22, v23
    v_add_f32 v18, v18, v19
    v_mov_b32 v24, v22
    v_mov_b32 v20, v18
    s_nop 1
    v_permlane32_swap_b32 v22, v24
    v_permlane32_swap_b32 v18, v20
    s_nop 0
    v_add_f32 v22, v22, v24
    v_add_f32 v18, v18, v20
    v_rcp_f32_e64 v22, v22
    v_rcp_f32 v18, v18
    s_nop 0
    v_pk_mul_f32 v[96:97], v[96:97], v[22:23] op_sel_hi:[1,0]
    v_pk_mul_f32 v[112:113], v[112:113], v[18:19] op_sel_hi:[1,0]
    v_pk_mul_f32 v[98:99], v[98:99], v[22:23] op_sel_hi:[1,0]
    v_pk_mul_f32 v[114:115], v[114:115], v[18:19] op_sel_hi:[1,0]
    v_pk_mul_f32 v[100:101], v[100:101], v[22:23] op_sel_hi:[1,0]
    v_pk_mul_f32 v[116:117], v[116:117], v[18:19] op_sel_hi:[1,0]
    v_pk_mul_f32 v[102:103], v[102:103], v[22:23] op_sel_hi:[1,0]
    v_pk_mul_f32 v[118:119], v[118:119], v[18:19] op_sel_hi:[1,0]
    v_pk_mul_f32 v[104:105], v[104:105], v[22:23] op_sel_hi:[1,0]
    v_pk_mul_f32 v[120:121], v[120:121], v[18:19] op_sel_hi:[1,0]
    v_pk_mul_f32 v[106:107], v[106:107], v[22:23] op_sel_hi:[1,0]
    v_pk_mul_f32 v[122:123], v[122:123], v[18:19] op_sel_hi:[1,0]
    v_pk_mul_f32 v[108:109], v[108:109], v[22:23] op_sel_hi:[1,0]
    v_pk_mul_f32 v[124:125], v[124:125], v[18:19] op_sel_hi:[1,0]
    v_pk_mul_f32 v[110:111], v[110:111], v[22:23] op_sel_hi:[1,0]
    v_pk_mul_f32 v[126:127], v[126:127], v[18:19] op_sel_hi:[1,0]
    v_cvt_pk_bf16_f32 v128, v96, v97
    v_cvt_pk_bf16_f32 v152, v112, v113
    v_cvt_pk_bf16_f32 v129, v98, v99
    v_cvt_pk_bf16_f32 v153, v114, v115
    v_cvt_pk_bf16_f32 v130, v100, v101
    v_cvt_pk_bf16_f32 v154, v116, v117
    v_cvt_pk_bf16_f32 v131, v102, v103
    v_cvt_pk_bf16_f32 v155, v118, v119
    v_cvt_pk_bf16_f32 v132, v104, v105
    v_cvt_pk_bf16_f32 v156, v120, v121
    v_cvt_pk_bf16_f32 v133, v106, v107
    v_cvt_pk_bf16_f32 v157, v122, v123
    v_cvt_pk_bf16_f32 v134, v108, v109
    v_cvt_pk_bf16_f32 v158, v124, v125
    v_cvt_pk_bf16_f32 v135, v110, v111
    v_cvt_pk_bf16_f32 v159, v126, v127
    s_branch FBACK_68
FSLOW_88:
    v_mfma_f32_32x32x16_bf16 v[80:95], v[160:163], v[152:155], 0
    v_mfma_f32_32x32x16_bf16 v[80:95], v[164:167], v[156:159], v[80:95]
    s_nop 15
    v_max3_f32 v14, v80, v81, v82
    v_min3_f32 v16, v80, v81, v82
    v_max3_f32 v14, v14, v83, v84
    v_min3_f32 v16, v16, v83, v84
    v_max3_f32 v14, v14, v85, v86
    v_min3_f32 v16, v16, v85, v86
    v_max3_f32 v14, v14, v87, v88
    v_min3_f32 v16, v16, v87, v88
    v_max3_f32 v14, v14, v89, v90
    v_min3_f32 v16, v16, v89, v90
    v_max3_f32 v14, v14, v91, v92
    v_min3_f32 v16, v16, v91, v92
    v_max3_f32 v14, v14, v93, v94
    v_min3_f32 v16, v16, v93, v94
    v_max_f32 v14, v14, v95
    v_min_f32 v16, v16, v95
    v_mov_b32 v18, v14
    v_mov_b32 v19, v16
    s_nop 1
    v_permlane32_swap_b32 v14, v18
    v_permlane32_swap_b32 v16, v19
    s_nop 0
    v_max_f32 v14, v14, v18
    v_min_f32 v16, v16, v19
    v_mul_f32 v14, s24, v14
    v_mul_f32 v16, s24, v16
    v_pk_fma_f32 v[96:97], v[80:81], s[24:25], v[16:17] op_sel_hi:[1,1,0] neg_lo:[1,0,0] neg_hi:[1,0,0]
    v_pk_fma_f32 v[80:81], v[80:81], s[24:25], v[14:15] op_sel_hi:[1,1,0] neg_lo:[0,0,1] neg_hi:[0,0,1]
    v_pk_fma_f32 v[98:99], v[82:83], s[24:25], v[16:17] op_sel_hi:[1,1,0] neg_lo:[1,0,0] neg_hi:[1,0,0]
    v_pk_fma_f32 v[82:83], v[82:83], s[24:25], v[14:15] op_sel_hi:[1,1,0] neg_lo:[0,0,1] neg_hi:[0,0,1]
    v_pk_fma_f32 v[100:101], v[84:85], s[24:25], v[16:17] op_sel_hi:[1,1,0] neg_lo:[1,0,0] neg_hi:[1,0,0]
    v_pk_fma_f32 v[84:85], v[84:85], s[24:25], v[14:15] op_sel_hi:[1,1,0] neg_lo:[0,0,1] neg_hi:[0,0,1]
    v_pk_fma_f32 v[102:103], v[86:87], s[24:25], v[16:17] op_sel_hi:[1,1,0] neg_lo:[1,0,0] neg_hi:[1,0,0]
    v_pk_fma_f32 v[86:87], v[86:87], s[24:25], v[14:15] op_sel_hi:[1,1,0] neg_lo:[0,0,1] neg_hi:[0,0,1]
    v_pk_fma_f32 v[104:105], v[88:89], s[24:25], v[16:17] op_sel_hi:[1,1,0] neg_lo:[1,0,0] neg_hi:[1,0,0]
    v_pk_fma_f32 v[88:89], v[88:89], s[24:25], v[14:15] op_sel_hi:[1,1,0] neg_lo:[0,0,1] neg_hi:[0,0,1]
    v_pk_fma_f32 v[106:107], v[90:91], s[24:25], v[16:17] op_sel_hi:[1,1,0] neg_lo:[1,0,0] neg_hi:[1,0,0]
    v_pk_fma_f32 v[90:91], v[90:91], s[24:25], v[14:15] op_sel_hi:[1,1,0] neg_lo:[0,0,1] neg_hi:[0,0,1]
    v_pk_fma_f32 v[108:109], v[92:93], s[24:25], v[16:17] op_sel_hi:[1,1,0] neg_lo:[1,0,0] neg_hi:[1,0,0]
    v_pk_fma_f32 v[92:93], v[92:93], s[24:25], v[14:15] op_sel_hi:[1,1,0] neg_lo:[0,0,1] neg_hi:[0,0,1]
    v_pk_fma_f32 v[110:111], v[94:95], s[24:25], v[16:17] op_sel_hi:[1,1,0] neg_lo:[1,0,0] neg_hi:[1,0,0]
    v_pk_fma_f32 v[94:95], v[94:95], s[24:25], v[14:15] op_sel_hi:[1,1,0] neg_lo:[0,0,1] neg_hi:[0,0,1]
    v_exp_f32 v96, v96
    v_exp_f32 v80, v80
    v_exp_f32 v97, v97
    v_exp_f32 v81, v81
    v_exp_f32 v98, v98
    v_exp_f32 v82, v82
    v_exp_f32 v99, v99
    v_exp_f32 v83, v83
    v_exp_f32 v100, v100
    v_exp_f32 v84, v84
    v_exp_f32 v101, v101
    v_exp_f32 v85, v85
    v_exp_f32 v102, v102
    v_exp_f32 v86, v86
    v_exp_f32 v103, v103
    v_exp_f32 v87, v87
    v_exp_f32 v104, v104
    v_exp_f32 v88, v88
    v_exp_f32 v105, v105
    v_exp_f32 v89, v89
    v_exp_f32 v106, v106
    v_exp_f32 v90, v90
    v_exp_f32 v107, v107
    v_exp_f32 v91, v91
    v_exp_f32 v108, v108
    v_exp_f32 v92, v92
    v_exp_f32 v109, v109
    v_exp_f32 v93, v93
    v_exp_f32 v110, v110
    v_exp_f32 v94, v94
    v_exp_f32 v111, v111
    v_exp_f32 v95, v95
    v_pk_add_f32 v[22:23], v[96:97], v[98:99]
    v_pk_add_f32 v[18:19], v[80:81], v[82:83]
    v_pk_add_f32 v[22:23], v[22:23], v[100:101]
    v_pk_add_f32 v[18:19], v[18:19], v[84:85]
    v_pk_add_f32 v[22:23], v[22:23], v[102:103]
    v_pk_add_f32 v[18:19], v[18:19], v[86:87]
    v_pk_add_f32 v[22:23], v[22:23], v[104:105]
    v_pk_add_f32 v[18:19], v[18:19], v[88:89]
    v_pk_add_f32 v[22:23], v[22:23], v[106:107]
    v_pk_add_f32 v[18:19], v[18:19], v[90:91]
    v_pk_add_f32 v[22:23], v[22:23], v[108:109]
    v_pk_add_f32 v[18:19], v[18:19], v[92:93]
    v_pk_add_f32 v[22:23], v[22:23], v[110:111]
    v_pk_add_f32 v[18:19], v[18:19], v[94:95]
    v_add_f32 v22, v22, v23
    v_add_f32 v18, v18, v19
    v_mov_b32 v24, v22
    v_mov_b32 v20, v18
    s_nop 1
    v_permlane32_swap_b32 v22, v24
    v_permlane32_swap_b32 v18, v20
    s_nop 0
    v_add_f32 v22, v22, v24
    v_add_f32 v18, v18, v20
    v_rcp_f32_e64 v22, v22
    v_rcp_f32 v18, v18
    s_nop 0
    v_pk_mul_f32 v[96:97], v[96:97], v[22:23] op_sel_hi:[1,0]
    v_pk_mul_f32 v[80:81], v[80:81], v[18:19] op_sel_hi:[1,0]
    v_pk_mul_f32 v[98:99], v[98:99], v[22:23] op_sel_hi:[1,0]
    v_pk_mul_f32 v[82:83], v[82:83], v[18:19] op_sel_hi:[1,0]
    v_pk_mul_f32 v[100:101], v[100:101], v[22:23] op_sel_hi:[1,0]
    v_pk_mul_f32 v[84:85], v[84:85], v[18:19] op_sel_hi:[1,0]
    v_pk_mul_f32 v[102:103], v[102:103], v[22:23] op_sel_hi:[1,0]
    v_pk_mul_f32 v[86:87], v[86:87], v[18:19] op_sel_hi:[1,0]
    v_pk_mul_f32 v[104:105], v[104:105], v[22:23] op_sel_hi:[1,0]
    v_pk_mul_f32 v[88:89], v[88:89], v[18:19] op_sel_hi:[1,0]
    v_pk_mul_f32 v[106:107], v[106:107], v[22:23] op_sel_hi:[1,0]
    v_pk_mul_f32 v[90:91], v[90:91], v[18:19] op_sel_hi:[1,0]
    v_pk_mul_f32 v[108:109], v[108:109], v[22:23] op_sel_hi:[1,0]
    v_pk_mul_f32 v[92:93], v[92:93], v[18:19] op_sel_hi:[1,0]
    v_pk_mul_f32 v[110:111], v[110:111], v[22:23] op_sel_hi:[1,0]
    v_pk_mul_f32 v[94:95], v[94:95], v[18:19] op_sel_hi:[1,0]
    v_cvt_pk_bf16_f32 v72, v96, v97
    v_cvt_pk_bf16_f32 v36, v80, v81
    v_cvt_pk_bf16_f32 v73, v98, v99
    v_cvt_pk_bf16_f32 v37, v82, v83
    v_cvt_pk_bf16_f32 v74, v100, v101
    v_cvt_pk_bf16_f32 v38, v84, v85
    v_cvt_pk_bf16_f32 v75, v102, v103
    v_cvt_pk_bf16_f32 v39, v86, v87
    v_cvt_pk_bf16_f32 v76, v104, v105
    v_cvt_pk_bf16_f32 v40, v88, v89
    v_cvt_pk_bf16_f32 v77, v106, v107
    v_cvt_pk_bf16_f32 v41, v90, v91
    v_cvt_pk_bf16_f32 v78, v108, v109
    v_cvt_pk_bf16_f32 v42, v92, v93
    v_cvt_pk_bf16_f32 v79, v110, v111
    v_cvt_pk_bf16_f32 v43, v94, v95
    s_branch FBACK_89
ATSLOW_90:
    s_mov_b32 s40, s41
    v_mov_b32 v14, 0xff7fffff
    v_mov_b32_e64 v19, 0
    s_mov_b32 s50, 0xffff0000
    s_mov_b32 s48, 0
    v_mov_b32 v112, 0
    v_mov_b32 v113, 0
    v_mov_b32 v114, 0
    v_mov_b32 v115, 0
    v_mov_b32 v116, 0
    v_mov_b32 v117, 0
    v_mov_b32 v118, 0
    v_mov_b32 v119, 0
    v_mov_b32 v120, 0
    v_mov_b32 v121, 0
    v_mov_b32 v122, 0
    v_mov_b32 v123, 0
    v_mov_b32 v124, 0
    v_mov_b32 v125, 0
    v_mov_b32 v126, 0
    v_mov_b32_e64 v127, 0
ATSL_108:
    buffer_load_dwordx4 v[48:51], v2, s[16:19], s40 offen offset:0 sc1
    buffer_load_dwordx4 v[64:67], v2, s[16:19], s40 offen offset:2048 sc1
    buffer_load_dwordx4 v[52:55], v2, s[16:19], s40 offen offset:1024 sc1
    buffer_load_dwordx4 v[68:71], v2, s[16:19], s40 offen offset:3072 sc1
    s_add_u32 s40, s40, 4096
    s_waitcnt vmcnt(0)
    v_mfma_f32_32x32x16_bf16 v[96:111], v[48:51], v[28:31], 0
    v_mfma_f32_32x32x16_bf16 v[96:111], v[52:55], v[32:35], v[96:111]
    s_nop 15
    v_max3_f32 v15, v96, v97, v14
    v_max3_f32 v15, v15, v98, v99
    v_max3_f32 v15, v15, v100, v101
    v_max3_f32 v15, v15, v102, v103
    v_max3_f32 v15, v15, v104, v105
    v_max3_f32 v15, v15, v106, v107
    v_max3_f32 v15, v15, v108, v109
    v_max3_f32 v15, v15, v110, v111
    v_mov_b32 v18, v15
    s_nop 1
    v_permlane32_swap_b32 v15, v18
    s_nop 1
    v_max_f32 v15, v15, v18
    v_sub_f32 v17, v14, v15
    v_exp_f32 v17, v17
    v_mov_b32 v14, v15
    v_sub_f32 v96, v96, v15
    v_sub_f32 v97, v97, v15
    v_sub_f32 v98, v98, v15
    v_sub_f32 v99, v99, v15
    v_sub_f32 v100, v100, v15
    v_sub_f32 v101, v101, v15
    v_sub_f32 v102, v102, v15
    v_sub_f32 v103, v103, v15
    v_sub_f32 v104, v104, v15
    v_sub_f32 v105, v105, v15
    v_sub_f32 v106, v106, v15
    v_sub_f32 v107, v107, v15
    v_sub_f32 v108, v108, v15
    v_sub_f32 v109, v109, v15
    v_sub_f32 v110, v110, v15
    v_sub_f32 v111, v111, v15
    v_exp_f32 v96, v96
    v_exp_f32 v97, v97
    v_exp_f32 v98, v98
    v_exp_f32 v99, v99
    v_exp_f32 v100, v100
    v_exp_f32 v101, v101
    v_exp_f32 v102, v102
    v_exp_f32 v103, v103
    v_exp_f32 v104, v104
    v_exp_f32 v105, v105
    v_exp_f32 v106, v106
    v_exp_f32 v107, v107
    v_exp_f32 v108, v108
    v_exp_f32 v109, v109
    v_exp_f32 v110, v110
    v_exp_f32 v111, v111
    v_mul_f32 v112, v17, v112
    v_mul_f32 v113, v17, v113
    v_mul_f32 v114, v17, v114
    v_mul_f32 v115, v17, v115
    v_mul_f32 v116, v17, v116
    v_mul_f32 v117, v17, v117
    v_mul_f32 v118, v17, v118
    v_mul_f32 v119, v17, v119
    v_mul_f32 v120, v17, v120
    v_mul_f32 v121, v17, v121
    v_mul_f32 v122, v17, v122
    v_mul_f32 v123, v17, v123
    v_mul_f32 v124, v17, v124
    v_mul_f32 v125, v17, v125
    v_mul_f32 v126, v17, v126
    v_mul_f32 v127, v17, v127
    v_and_b32 v96, s50, v96
    v_and_b32 v97, s50, v97
    v_and_b32 v98, s50, v98
    v_and_b32 v99, s50, v99
    v_and_b32 v100, s50, v100
    v_and_b32 v101, s50, v101
    v_and_b32 v102, s50, v102
    v_and_b32 v103, s50, v103
    v_and_b32 v104, s50, v104
    v_and_b32 v105, s50, v105
    v_and_b32 v106, s50, v106
    v_and_b32 v107, s50, v107
    v_and_b32 v108, s50, v108
    v_and_b32 v109, s50, v109
    v_and_b32 v110, s50, v110
    v_and_b32 v111, s50, v111
    v_mul_f32 v19, v17, v19
    v_add_f32 v19, v19, v96
    v_add_f32 v19, v19, v97
    v_add_f32 v19, v19, v98
    v_add_f32 v19, v19, v99
    v_add_f32 v19, v19, v100
    v_add_f32 v19, v19, v101
    v_add_f32 v19, v19, v102
    v_add_f32 v19, v19, v103
    v_add_f32 v19, v19, v104
    v_add_f32 v19, v19, v105
    v_add_f32 v19, v19, v106
    v_add_f32 v19, v19, v107
    v_add_f32 v19, v19, v108
    v_add_f32 v19, v19, v109
    v_add_f32 v19, v19, v110
    v_add_f32_e64 v19, v19, v111
    v_smfmac_f32_32x32x32_bf16 v[112:127], v[64:67], v[96:103], v26
    v_smfmac_f32_32x32x32_bf16 v[112:127], v[68:71], v[104:111], v26
    s_nop 15
    s_add_u32 s48, s48, 1
    s_cmp_lt_u32 s48, 64
    s_cbranch_scc1 ATSL_108
    v_mov_b32 v18, v19
    s_nop 1
    v_permlane32_swap_b32 v19, v18
    s_nop 1
    v_add_f32 v144, v19, v18
    v_rcp_f32 v16, v144
    s_nop 0
    s_branch ATFIN_91
CODE_END:
.section .rodata,"a"
.p2align 6
.amdhsa_kernel concat_heads__linear_kernel_hedgehog__mha_block__prompt_kernel
.amdhsa_next_free_vgpr 256
.amdhsa_next_free_sgpr 102
.amdhsa_accum_offset 256
.amdhsa_group_segment_fixed_size 0
.amdhsa_kernarg_size 80
.amdhsa_user_sgpr_count 2
.amdhsa_user_sgpr_kernarg_segment_ptr 1
.amdhsa_system_sgpr_workgroup_id_x 1
.end_amdhsa_kernel
```
